```python
import torch

def _softmax(x, axis=-1):
    return torch.softmax(x, dim=axis)

def _gelu(x):
    return torch.nn.functional.gelu(x, approximate='tanh')

def _silu(x):
    return torch.nn.functional.silu(x)

def _sigmoid(x):
    return torch.sigmoid(x)

def _layernorm(x, axis=-1, eps=1e-05):
    m = x.mean(dim=axis, keepdim=True)
    v = x.var(dim=axis, keepdim=True, unbiased=False)
    return (x - m) / torch.sqrt(v + eps)

def _scatter_add(tgt, idx, src, axis=0):
    return tgt.clone().index_add_(axis, idx, src)

def _segment_sum(src, seg, n):
    out = torch.zeros((n,) + src.shape[1:], dtype=src.dtype)
    return out.index_add_(0, seg, src)

def _pad(x, pw):
    flat = tuple((v for pair in reversed(pw) for v in pair))
    return torch.nn.functional.pad(x, flat)
kernel_name = 'recurrent_scan__spectral_gfnet__mixer_gmlp__prompt'

def setup_inputs():

    _w = lambda a: (lambda t: t.to(torch.bfloat16) if t.is_floating_point() else t)(torch.as_tensor(a))

    def _A_setup():
        B, S, D = (1, 2048, 512)
        Df = D // 2 + 1
        return {'x': _w((lambda *s: torch.randn(*s, dtype=torch.bfloat16) * 0.05)(B, S, D)), 'w_r': _w((lambda *s: torch.randn(*s, dtype=torch.bfloat16) * 0.2)(S, Df) * 0.02), 'w_i': _w((lambda *s: torch.randn(*s, dtype=torch.bfloat16) * 0.2)(S, Df) * 0.02)}
    _A_in = _A_setup()

    def _B_setup():
        B, S, D, F = (1, 2048, 512, 1376)
        Fh = F // 2
        return {'x': _w((lambda *s: torch.randn(*s, dtype=torch.bfloat16) * 0.05)(B, S, D)), 'w_in': _w((lambda *s: torch.randn(*s, dtype=torch.bfloat16) * 0.4)(D, 2 * Fh)), 'w_sp': _w(0.01 * (lambda *s: torch.randn(*s, dtype=torch.bfloat16) * 0.4)(S, S)), 'b_sp': _w(1.0 + 0.01 * (lambda *s: torch.randn(*s, dtype=torch.bfloat16) * 0.1)(S)), 'w_out': _w((lambda *s: torch.randn(*s, dtype=torch.bfloat16) * 0.1)(Fh, D))}
    _B_in = _B_setup()
    return {'A_x': _A_in['x'], 'A_w_r': _A_in['w_r'], 'A_w_i': _A_in['w_i'], 'B_x': _B_in['x'], 'B_w_in': _B_in['w_in'], 'B_w_sp': _B_in['w_sp'], 'B_b_sp': _B_in['b_sp'], 'B_w_out': _B_in['w_out']}

def reference(A_x, A_w_r, A_w_i, B_x, B_w_in, B_w_sp, B_b_sp, B_w_out):

    def _A_ref(x, w_r, w_i):
        B, S, D = x.shape
        X = (lambda x, axes=(-2, -1): torch.fft.rfft2(x.float(), dim=axes))(x, axes=(-2, -1))
        W = w_r + 1j * w_i
        X = X * W
        y = (lambda x, s, axes=(-2, -1): torch.fft.irfft2(x, s=s, dim=axes).to(torch.bfloat16))(X, (S, D), axes=(-2, -1))
        return y

    def _B_ref(x, w_in, w_sp, b_sp, w_out):
        B, S, D = x.shape
        F = w_in.shape[-1]
        Fh = F // 2
        z = _gelu(torch.einsum('bsd,df->bsf', x, w_in))
        z1 = z[..., :Fh].clone()
        z2 = _layernorm(z[..., Fh:], axis=-1)
        g = torch.einsum('ts,bsf->btf', w_sp, z2) + b_sp[None, :, None]
        return torch.einsum('bsf,fd->bsd', z1 * g, w_out)
    x = A_x
    xn = _layernorm(x, axis=-1)
    s = _A_ref(xn, A_w_r, A_w_i)
    g = _silu(_B_ref(xn, B_w_in, B_w_sp, B_b_sp, B_w_out))
    return x + s * g
```

```asm
; @launch grid=(256,1,1) block=(512,1,1) lds=163840
.amdgcn_target "amdgcn-amd-amdhsa--gfx950"
.text
.globl recurrent_scan__spectral_gfnet__mixer_gmlp__prompt_kernel
.p2align 8
.type recurrent_scan__spectral_gfnet__mixer_gmlp__prompt_kernel,@function
recurrent_scan__spectral_gfnet__mixer_gmlp__prompt_kernel:
    s_cmp_ge_u32 s2, 256
    s_cbranch_scc1 L_exit
    s_load_dwordx16 s[64:79], s[0:1], 0
    s_load_dwordx4 s[80:83], s[0:1], 64
    s_load_dwordx2 s[84:85], s[0:1], 80
    s_getpc_b64 s[4:5]
L_soft_pc:
    s_lshr_b32 s3, s2, 3
    s_mul_i32 s3, s3, ((L_end-L_soft_pc)/32+127)/128*128
    v_and_b32 v1, 63, v0
    v_lshrrev_b32 v2, 6, v0
    v_min_u32 v3, ((L_end-L_soft_pc)/32+127)/128-1, v0
    v_lshlrev_b32 v3, 7, v3
    v_add_u32 v3, s3, v3
    v_min_u32 v3, L_end-L_soft_pc-4, v3
    v_readfirstlane_b32 s44, v2
    global_load_dword v3, v3, s[4:5]
    s_and_b32 s4, s2, 7
    s_lshr_b32 s5, s2, 3
    s_and_b32 s6, s4, 1
    s_cmp_ge_u32 s5, 22
    s_cbranch_scc1 L_p1_light
    s_lshr_b32 s46, s4, 1
    s_lshl_b32 s46, s46, 2
    s_lshr_b32 s47, s5, 2
    s_mul_i32 s3, s6, 6
    s_add_u32 s47, s47, s3
    s_and_b32 s3, s5, 3
    s_lshl_b32 s7, s6, 1
    s_add_u32 s7, s7, s3
    s_cmp_ge_u32 s5, 20
    s_cselect_b32 s47, 5, s47
    s_cselect_b32 s3, s7, s3
    s_add_u32 s46, s46, s3
    s_lshl_b32 s51, s44, 10
    s_lshl_b32 s54, s46, 17
    v_lshrrev_b32 v5, 4, v1
    s_lshl_b32 s3, s44, 2
    v_add_u32 v5, s3, v5
    v_xor_b32 v6, v5, v1
    v_and_b32 v6, 15, v6
    v_lshlrev_b32 v6, 4, v6
    v_lshl_add_u32 v4, v5, 10, v6
    v_lshrrev_b32 v5, 2, v1
    v_and_b32 v5, 4, v5
    v_and_b32 v6, 7, v1
    v_xor_b32 v6, v5, v6
    v_lshrrev_b32 v5, 3, v1
    v_mul_u32_u24 v5, 2752, v5
    v_lshl_add_u32 v8, v6, 4, v5
    s_cmp_eq_u32 s47, 0
    s_cselect_b32 s3, 2, 0
    v_cmp_gt_u32 vcc, s3, v6
    v_mov_b32 v5, 0x40000000
    s_nop 0
    v_cndmask_b32 v7, v8, v5, vcc
    s_mul_i32 s3, s44, 22016
    s_lshl_b32 s53, s47, 7
    s_add_u32 s53, s53, s3
    s_waitcnt lgkmcnt(0)
    s_mov_b64 s[8:9], s[64:65]
    s_mov_b32 s10, 2097152
    s_mov_b32 s11, 0x00020000
    s_mov_b64 s[12:13], s[72:73]
    s_mov_b32 s14, 1409024
    s_mov_b32 s15, 0x00020000
    s_mov_b64 s[40:41], s[80:81]
    s_mov_b32 s42, 2097152
    s_mov_b32 s43, 0x00020000
    s_mov_b32 s80, s53
    s_add_u32 m0, s51, 0
    s_add_u32 s3, s54, 0
    buffer_load_dwordx4 v4, s[8:11], s3 offen lds
    s_add_u32 m0, s51, 8192
    s_add_u32 s3, s54, 32768
    buffer_load_dwordx4 v4, s[8:11], s3 offen lds
    s_add_u32 m0, s51, 16384
    s_add_u32 s3, s54, 65536
    buffer_load_dwordx4 v4, s[8:11], s3 offen lds
    s_add_u32 m0, s51, 24576
    s_add_u32 s3, s54, 98304
    buffer_load_dwordx4 v4, s[8:11], s3 offen lds
    s_add_u32 m0, s51, 98304
    s_add_u32 s3, s80, 1344
    buffer_load_dwordx4 v7, s[12:15], s3 offen lds
    s_add_u32 m0, s51, 106496
    s_add_u32 s3, s80, 177472
    buffer_load_dwordx4 v7, s[12:15], s3 offen lds
    s_add_u32 s4, s84, 14680064
    s_addc_u32 s5, s85, 0
    s_load_dword s45, s[4:5], 0
    s_add_u32 s52, s46, s47
    s_mul_i32 s3, s52, 86
    s_lshr_b32 s3, s3, 8
    s_mul_i32 s3, s3, 3
    s_sub_u32 s52, s52, s3
    s_add_u32 s52, s52, 1
    s_lshl_b32 s3, s52, 8
    s_add_u32 s57, s3, s54
    s_mul_i32 s3, s52, 352256
    s_add_u32 s81, s3, s53
    s_cmp_eq_u32 s52, 3
    s_cselect_b32 s52, 0, s52
    s_add_u32 s52, s52, 1
    s_lshl_b32 s3, s52, 8
    s_add_u32 s58, s3, s54
    s_mul_i32 s3, s52, 352256
    s_add_u32 s82, s3, s53
    s_cmp_eq_u32 s52, 3
    s_cselect_b32 s52, 0, s52
    s_add_u32 s52, s52, 1
    s_lshl_b32 s3, s52, 8
    s_add_u32 s59, s3, s54
    s_mul_i32 s3, s52, 352256
    s_add_u32 s83, s3, s53
    s_mov_b64 s[16:17], s[84:85]
    s_mov_b32 s18, 16777216
    s_mov_b32 s19, 0x00020000
    s_mov_b64 s[20:21], s[74:75]
    s_mov_b32 s22, 8388608
    s_mov_b32 s23, 0x00020000
    s_mov_b64 s[24:25], s[66:67]
    s_mov_b32 s26, 1052672
    s_mov_b32 s27, 0x00020000
    s_mov_b64 s[28:29], s[68:69]
    s_mov_b32 s30, 1052672
    s_mov_b32 s31, 0x00020000
    s_mov_b64 s[32:33], s[76:77]
    s_mov_b32 s34, 4096
    s_mov_b32 s35, 0x00020000
    s_mov_b64 s[36:37], s[78:79]
    s_mov_b32 s38, 704512
    s_mov_b32 s39, 0x00020000
    v_and_b32 v10, 31, v1
    v_lshrrev_b32 v11, 5, v1
    v_and_b32 v5, 0x13, v10
    v_lshrrev_b32 v6, 1, v10
    v_and_b32 v6, 4, v6
    v_or_b32 v5, v5, v6
    v_lshlrev_b32 v6, 1, v10
    v_and_or_b32 v5, v6, 8, v5
    s_and_b32 s48, s44, 3
    s_lshr_b32 s49, s44, 2
    v_lshlrev_b32 v14, 4, v5
    v_and_b32 v6, 15, v5
    v_xor_b32 v6, v6, v11
    s_lshl_b32 s3, s44, 1
    v_xor_b32 v6, s3, v6
    v_lshlrev_b32 v6, 4, v6
    s_lshl_b32 s3, s48, 13
    v_lshl_add_u32 v12, v5, 8, v6
    v_add_u32 v12, s3, v12
    v_bfe_u32 v6, v1, 2, 2
    v_lshl_add_u32 v6, v11, 3, v6
    v_lshlrev_b32 v13, 7, v6
    v_bfe_u32 v6, v1, 4, 1
    v_bfe_u32 v9, v1, 1, 1
    v_lshl_or_b32 v6, v6, 1, v9
    s_lshl_b32 s3, s49, 2
    v_or_b32 v6, s3, v6
    v_bfe_u32 v9, v1, 3, 1
    v_lshlrev_b32 v9, 2, v9
    v_xor_b32 v6, v6, v9
    v_lshl_add_u32 v13, v6, 4, v13
    v_and_b32 v6, 1, v1
    v_lshl_add_u32 v13, v6, 3, v13
    s_lshl_b32 s3, s44, 11
    s_add_u32 s3, s3, 98304
    v_add_u32 v40, s3, v13
    v_xor_b32 v41, 2048, v40
    v_xor_b32 v42, 4096, v40
    v_xor_b32 v43, 6144, v40
    v_xor_b32 v44, 8192, v40
    v_xor_b32 v45, 10240, v40
    v_xor_b32 v46, 12288, v40
    v_xor_b32 v47, 14336, v40
    v_lshlrev_b32 v5, 2, v11
    v_sub_u32 v5, v10, v5
    v_mov_b32 v6, 0x3f80
    v_mov_b32 v9, 0x3f800000
    v_cmp_eq_u32 vcc, 0, v5
    v_cmp_eq_u32 s[4:5], 1, v5
    s_nop 0
    v_cndmask_b32 v80, 0, v6, vcc
    v_cndmask_b32 v80, v80, v9, s[4:5]
    v_cmp_eq_u32 vcc, 2, v5
    v_cmp_eq_u32 s[4:5], 3, v5
    s_nop 0
    v_cndmask_b32 v81, 0, v6, vcc
    v_cndmask_b32 v81, v81, v9, s[4:5]
    v_cmp_eq_u32 vcc, 8, v5
    v_cmp_eq_u32 s[4:5], 9, v5
    s_nop 0
    v_cndmask_b32 v82, 0, v6, vcc
    v_cndmask_b32 v82, v82, v9, s[4:5]
    v_cmp_eq_u32 vcc, 10, v5
    v_cmp_eq_u32 s[4:5], 11, v5
    s_nop 0
    v_cndmask_b32 v83, 0, v6, vcc
    v_cndmask_b32 v83, v83, v9, s[4:5]
    v_cmp_eq_u32 vcc, 16, v5
    v_cmp_eq_u32 s[4:5], 17, v5
    s_nop 0
    v_cndmask_b32 v84, 0, v6, vcc
    v_cndmask_b32 v84, v84, v9, s[4:5]
    v_cmp_eq_u32 vcc, 18, v5
    v_cmp_eq_u32 s[4:5], 19, v5
    s_nop 0
    v_cndmask_b32 v85, 0, v6, vcc
    v_cndmask_b32 v85, v85, v9, s[4:5]
    v_cmp_eq_u32 vcc, 24, v5
    v_cmp_eq_u32 s[4:5], 25, v5
    s_nop 0
    v_cndmask_b32 v86, 0, v6, vcc
    v_cndmask_b32 v86, v86, v9, s[4:5]
    v_cmp_eq_u32 vcc, 26, v5
    v_cmp_eq_u32 s[4:5], 27, v5
    s_nop 0
    v_cndmask_b32 v87, 0, v6, vcc
    v_cndmask_b32 v87, v87, v9, s[4:5]
    s_mov_b32 s55, 0x3f803f80
    v_mov_b32 v18, 0
    v_mov_b32 v19, 0
    v_mov_b32 v50, 0
    v_mov_b32 v51, 0
    v_mov_b32 v54, 0
    v_mov_b32 v55, 0
    s_lshl_b32 s3, s49, 10
    s_add_u32 s3, s3, 79872
    v_lshl_add_u32 v37, v10, 5, s3
    s_lshl_b32 s4, s48, 3
    v_lshl_add_u32 v27, v11, 2, v37
    v_add_u32 v27, s4, v27
    v_lshl_add_u32 v37, v11, 4, v37
    s_lshl_b32 s3, s48, 9
    s_add_u32 s3, s3, 83968
    v_lshl_add_u32 v24, v10, 4, s3
    s_lshl_b32 s4, s49, 3
    v_add_u32 v25, s4, v24
    v_lshlrev_b32 v9, 4, v10
    v_lshl_add_u32 v13, v11, 30, v9
    v_lshl_add_u32 v21, v11, 11, v9
    s_mul_i32 s56, s46, 22528
    s_lshl_b32 s3, s48, 9
    s_add_u32 s56, s56, s3
    s_add_u32 s56, s56, 13631488
    s_lshl_b32 s4, s46, 11
    s_add_u32 s4, s4, s3
    s_add_u32 s50, s4, 14155776
    s_lshl_b32 s63, s47, 8
    s_lshl_b32 s3, s46, 2
    s_add_u32 s63, s63, s3
    s_add_u32 s63, s63, 14684160
    s_and_b32 s4, s2, 7
    s_lshr_b32 s5, s2, 3
    s_and_b32 s6, s4, 1
    s_lshr_b32 s72, s5, 3
    s_and_b32 s68, s5, 7
    s_lshl_b32 s67, s4, 2
    s_add_u32 s67, s67, s72
    s_and_b32 s3, s5, 3
    s_lshl_b32 s3, s3, 1
    s_bfe_u32 s64, s5, 0x10002
    s_xor_b32 s64, s64, s6
    s_xor_b32 s64, s64, 1
    s_add_u32 s3, s3, s64
    s_cmp_eq_u32 s72, 2
    s_cselect_b32 s3, s3, s68
    s_lshr_b32 s64, s4, 1
    s_lshl_b32 s64, s64, 3
    s_add_u32 s64, s64, s3
    s_xor_b32 s3, s3, s6
    s_and_b32 s3, s3, 1
    s_xor_b32 s3, s3, 1
    s_sub_u32 s65, 22, s3
    s_mul_i32 s65, s65, s6
    s_mul_i32 s4, s72, 5
    s_add_u32 s65, s65, s4
    s_cmp_eq_u32 s72, 3
    s_cselect_b32 s4, s3, 0
    s_add_u32 s65, s65, s4
    s_add_u32 s3, s3, s72
    s_cmp_ge_u32 s3, 3
    s_cselect_b32 s66, 6, 5
    s_lshl_b32 s69, s64, 13
    s_lshl_b32 s3, s44, 9
    s_add_u32 s69, s69, s3
    s_mul_i32 s70, s44, 8448
    s_barrier
    s_add_u32 m0, s51, 32768
    s_add_u32 s3, s57, 0
    buffer_load_dwordx4 v4, s[8:11], s3 offen lds
    s_add_u32 m0, s51, 40960
    s_add_u32 s3, s57, 32768
    buffer_load_dwordx4 v4, s[8:11], s3 offen lds
    s_add_u32 m0, s51, 49152
    s_add_u32 s3, s57, 65536
    buffer_load_dwordx4 v4, s[8:11], s3 offen lds
    s_add_u32 m0, s51, 57344
    s_add_u32 s3, s57, 98304
    buffer_load_dwordx4 v4, s[8:11], s3 offen lds
    s_add_u32 m0, s51, 114688
    s_add_u32 s3, s81, 1344
    buffer_load_dwordx4 v7, s[12:15], s3 offen lds
    s_add_u32 m0, s51, 122880
    s_add_u32 s3, s81, 177472
    buffer_load_dwordx4 v7, s[12:15], s3 offen lds
    s_waitcnt lgkmcnt(0)
    s_mul_i32 s45, s45, 0x9E3779B1
    s_add_u32 s45, s45, 0x7F4A7C15
    s_waitcnt vmcnt(6)
    s_barrier
    v_add_u32 v20, 0, v12
    v_xor_b32 v22, 0, v20
    ds_read_b128 v[128:131], v22
    ds_read_b64_tr_b16 v[88:89], v40 offset:0
    ds_read_b64_tr_b16 v[90:91], v40 offset:512
    v_xor_b32 v23, 32, v20
    ds_read_b128 v[132:135], v23
    ds_read_b64_tr_b16 v[68:69], v41 offset:0
    ds_read_b64_tr_b16 v[70:71], v41 offset:512
    v_xor_b32 v22, 64, v20
    ds_read_b128 v[136:139], v22
    ds_read_b64_tr_b16 v[72:73], v42 offset:0
    ds_read_b64_tr_b16 v[74:75], v42 offset:512
    v_xor_b32 v23, 96, v20
    ds_read_b128 v[140:143], v23
    ds_read_b64_tr_b16 v[76:77], v43 offset:0
    ds_read_b64_tr_b16 v[78:79], v43 offset:512
    s_waitcnt lgkmcnt(9)
    v_mfma_f32_32x32x16_bf16 v[96:111], v[88:91], v[128:131], 0
    s_add_u32 m0, s51, 65536
    s_add_u32 s3, s58, 0
    buffer_load_dwordx4 v4, s[8:11], s3 offen lds
    v_xor_b32 v22, 128, v20
    ds_read_b128 v[144:147], v22
    ds_read_b64_tr_b16 v[92:93], v44 offset:0
    ds_read_b64_tr_b16 v[94:95], v44 offset:512
    s_waitcnt lgkmcnt(9)
    v_mfma_f32_32x32x16_bf16 v[96:111], v[68:71], v[132:135], v[96:111]
    s_add_u32 m0, s51, 73728
    s_add_u32 s3, s58, 32768
    buffer_load_dwordx4 v4, s[8:11], s3 offen lds
    v_xor_b32 v23, 160, v20
    ds_read_b128 v[148:151], v23
    ds_read_b64_tr_b16 v[64:65], v45 offset:0
    ds_read_b64_tr_b16 v[66:67], v45 offset:512
    s_waitcnt lgkmcnt(9)
    v_mfma_f32_32x32x16_bf16 v[96:111], v[72:75], v[136:139], v[96:111]
    s_add_u32 m0, s51, 81920
    s_add_u32 s3, s58, 65536
    buffer_load_dwordx4 v4, s[8:11], s3 offen lds
    v_xor_b32 v22, 192, v20
    ds_read_b128 v[152:155], v22
    ds_read_b64_tr_b16 v[68:69], v46 offset:0
    ds_read_b64_tr_b16 v[70:71], v46 offset:512
    s_waitcnt lgkmcnt(9)
    v_mfma_f32_32x32x16_bf16 v[96:111], v[76:79], v[140:143], v[96:111]
    s_add_u32 m0, s51, 90112
    s_add_u32 s3, s58, 98304
    buffer_load_dwordx4 v4, s[8:11], s3 offen lds
    v_xor_b32 v23, 224, v20
    ds_read_b128 v[156:159], v23
    ds_read_b64_tr_b16 v[72:73], v47 offset:0
    ds_read_b64_tr_b16 v[74:75], v47 offset:512
    s_waitcnt lgkmcnt(9)
    v_mfma_f32_32x32x16_bf16 v[96:111], v[92:95], v[144:147], v[96:111]
    s_add_u32 m0, s51, 131072
    s_add_u32 s3, s82, 1344
    buffer_load_dwordx4 v7, s[12:15], s3 offen lds
    v_dot2c_f32_bf16 v18, s55, v88
    v_dot2c_f32_bf16 v18, s55, v89
    v_dot2c_f32_bf16 v18, s55, v90
    v_dot2c_f32_bf16 v18, s55, v91
    v_dot2c_f32_bf16 v18, s55, v92
    v_dot2c_f32_bf16 v18, s55, v93
    v_dot2c_f32_bf16 v18, s55, v94
    v_dot2c_f32_bf16 v18, s55, v95
    s_waitcnt vmcnt(5)
    s_barrier
    v_add_u32 v20, 32768, v12
    v_xor_b32 v22, 0, v20
    ds_read_b128 v[160:163], v22
    ds_read_b64_tr_b16 v[88:89], v40 offset:16384
    ds_read_b64_tr_b16 v[90:91], v40 offset:16896
    s_waitcnt lgkmcnt(9)
    v_mfma_f32_32x32x16_bf16 v[96:111], v[64:67], v[148:151], v[96:111]
    s_add_u32 m0, s51, 139264
    s_add_u32 s3, s82, 177472
    buffer_load_dwordx4 v7, s[12:15], s3 offen lds
    v_xor_b32 v23, 32, v20
    ds_read_b128 v[164:167], v23
    ds_read_b64_tr_b16 v[76:77], v41 offset:16384
    ds_read_b64_tr_b16 v[78:79], v41 offset:16896
    s_waitcnt lgkmcnt(9)
    v_mfma_f32_32x32x16_bf16 v[96:111], v[68:71], v[152:155], v[96:111]
    s_add_u32 m0, s51, 147456
    s_add_u32 s3, s83, 1344
    buffer_load_dwordx4 v7, s[12:15], s3 offen lds
    v_xor_b32 v22, 64, v20
    ds_read_b128 v[168:171], v22
    ds_read_b64_tr_b16 v[64:65], v42 offset:16384
    ds_read_b64_tr_b16 v[66:67], v42 offset:16896
    s_waitcnt lgkmcnt(9)
    v_mfma_f32_32x32x16_bf16 v[96:111], v[72:75], v[156:159], v[96:111]
    s_add_u32 m0, s51, 155648
    s_add_u32 s3, s83, 177472
    buffer_load_dwordx4 v7, s[12:15], s3 offen lds
    s_barrier
    v_xor_b32 v23, 96, v20
    ds_read_b128 v[172:175], v23
    ds_read_b64_tr_b16 v[68:69], v43 offset:16384
    ds_read_b64_tr_b16 v[70:71], v43 offset:16896
    s_waitcnt lgkmcnt(9)
    v_mfma_f32_32x32x16_bf16 v[96:111], v[88:91], v[160:163], v[96:111]
    s_add_u32 m0, s51, 0
    s_add_u32 s3, s59, 0
    buffer_load_dwordx4 v4, s[8:11], s3 offen lds
    v_xor_b32 v22, 128, v20
    ds_read_b128 v[176:179], v22
    ds_read_b64_tr_b16 v[92:93], v44 offset:16384
    ds_read_b64_tr_b16 v[94:95], v44 offset:16896
    s_waitcnt lgkmcnt(9)
    v_mfma_f32_32x32x16_bf16 v[96:111], v[76:79], v[164:167], v[96:111]
    s_add_u32 m0, s51, 8192
    s_add_u32 s3, s59, 32768
    buffer_load_dwordx4 v4, s[8:11], s3 offen lds
    v_xor_b32 v23, 160, v20
    ds_read_b128 v[180:183], v23
    ds_read_b64_tr_b16 v[72:73], v45 offset:16384
    ds_read_b64_tr_b16 v[74:75], v45 offset:16896
    s_waitcnt lgkmcnt(9)
    v_mfma_f32_32x32x16_bf16 v[96:111], v[64:67], v[168:171], v[96:111]
    s_add_u32 m0, s51, 16384
    s_add_u32 s3, s59, 65536
    buffer_load_dwordx4 v4, s[8:11], s3 offen lds
    v_xor_b32 v22, 192, v20
    ds_read_b128 v[184:187], v22
    ds_read_b64_tr_b16 v[76:77], v46 offset:16384
    ds_read_b64_tr_b16 v[78:79], v46 offset:16896
    s_waitcnt lgkmcnt(9)
    v_mfma_f32_32x32x16_bf16 v[96:111], v[68:71], v[172:175], v[96:111]
    s_add_u32 m0, s51, 24576
    s_add_u32 s3, s59, 98304
    buffer_load_dwordx4 v4, s[8:11], s3 offen lds
    v_xor_b32 v23, 224, v20
    ds_read_b128 v[188:191], v23
    ds_read_b64_tr_b16 v[64:65], v47 offset:16384
    ds_read_b64_tr_b16 v[66:67], v47 offset:16896
    s_waitcnt lgkmcnt(9)
    v_mfma_f32_32x32x16_bf16 v[96:111], v[92:95], v[176:179], v[96:111]
    v_dot2c_f32_bf16 v18, s55, v88
    v_dot2c_f32_bf16 v18, s55, v89
    v_dot2c_f32_bf16 v18, s55, v90
    v_dot2c_f32_bf16 v18, s55, v91
    v_dot2c_f32_bf16 v18, s55, v92
    v_dot2c_f32_bf16 v18, s55, v93
    v_dot2c_f32_bf16 v18, s55, v94
    v_dot2c_f32_bf16 v18, s55, v95
    s_waitcnt vmcnt(6)
    s_barrier
    v_add_u32 v20, 65536, v12
    v_xor_b32 v22, 0, v20
    ds_read_b128 v[192:195], v22
    ds_read_b64_tr_b16 v[88:89], v40 offset:32768
    ds_read_b64_tr_b16 v[90:91], v40 offset:33280
    s_waitcnt lgkmcnt(9)
    v_mfma_f32_32x32x16_bf16 v[96:111], v[72:75], v[180:183], v[96:111]
    v_xor_b32 v23, 32, v20
    ds_read_b128 v[196:199], v23
    ds_read_b64_tr_b16 v[68:69], v41 offset:32768
    ds_read_b64_tr_b16 v[70:71], v41 offset:33280
    s_waitcnt lgkmcnt(9)
    v_mfma_f32_32x32x16_bf16 v[96:111], v[76:79], v[184:187], v[96:111]
    s_add_u32 m0, s51, 98304
    s_add_u32 s3, s80, 0
    buffer_load_dwordx4 v8, s[12:15], s3 offen lds
    v_xor_b32 v22, 64, v20
    ds_read_b128 v[200:203], v22
    ds_read_b64_tr_b16 v[72:73], v42 offset:32768
    ds_read_b64_tr_b16 v[74:75], v42 offset:33280
    s_waitcnt lgkmcnt(9)
    v_mfma_f32_32x32x16_bf16 v[96:111], v[64:67], v[188:191], v[96:111]
    v_xor_b32 v23, 96, v20
    ds_read_b128 v[204:207], v23
    ds_read_b64_tr_b16 v[76:77], v43 offset:32768
    ds_read_b64_tr_b16 v[78:79], v43 offset:33280
    s_waitcnt lgkmcnt(9)
    v_mfma_f32_32x32x16_bf16 v[96:111], v[88:91], v[192:195], v[96:111]
    s_add_u32 m0, s51, 106496
    s_add_u32 s3, s80, 176128
    buffer_load_dwordx4 v8, s[12:15], s3 offen lds
    v_xor_b32 v22, 128, v20
    ds_read_b128 v[208:211], v22
    ds_read_b64_tr_b16 v[92:93], v44 offset:32768
    ds_read_b64_tr_b16 v[94:95], v44 offset:33280
    s_waitcnt lgkmcnt(9)
    v_mfma_f32_32x32x16_bf16 v[96:111], v[68:71], v[196:199], v[96:111]
    v_xor_b32 v23, 160, v20
    ds_read_b128 v[212:215], v23
    ds_read_b64_tr_b16 v[64:65], v45 offset:32768
    ds_read_b64_tr_b16 v[66:67], v45 offset:33280
    s_waitcnt lgkmcnt(9)
    v_mfma_f32_32x32x16_bf16 v[96:111], v[72:75], v[200:203], v[96:111]
    v_xor_b32 v22, 192, v20
    ds_read_b128 v[216:219], v22
    ds_read_b64_tr_b16 v[68:69], v46 offset:32768
    ds_read_b64_tr_b16 v[70:71], v46 offset:33280
    s_waitcnt lgkmcnt(9)
    v_mfma_f32_32x32x16_bf16 v[96:111], v[76:79], v[204:207], v[96:111]
    buffer_load_dwordx4 v[56:59], v14, s[16:19], s50 offen sc1
    v_xor_b32 v23, 224, v20
    ds_read_b128 v[220:223], v23
    ds_read_b64_tr_b16 v[72:73], v47 offset:32768
    ds_read_b64_tr_b16 v[74:75], v47 offset:33280
    s_waitcnt lgkmcnt(9)
    v_mfma_f32_32x32x16_bf16 v[96:111], v[92:95], v[208:211], v[96:111]
    v_dot2c_f32_bf16 v18, s55, v88
    v_dot2c_f32_bf16 v18, s55, v89
    v_dot2c_f32_bf16 v18, s55, v90
    v_dot2c_f32_bf16 v18, s55, v91
    v_dot2c_f32_bf16 v18, s55, v92
    v_dot2c_f32_bf16 v18, s55, v93
    v_dot2c_f32_bf16 v18, s55, v94
    v_dot2c_f32_bf16 v18, s55, v95
    s_waitcnt vmcnt(3)
    s_barrier
    v_add_u32 v20, 0, v12
    v_xor_b32 v22, 0, v20
    ds_read_b128 v[224:227], v22
    ds_read_b64_tr_b16 v[88:89], v40 offset:49152
    ds_read_b64_tr_b16 v[90:91], v40 offset:49664
    s_waitcnt lgkmcnt(9)
    v_mfma_f32_32x32x16_bf16 v[96:111], v[64:67], v[212:215], v[96:111]
    v_xor_b32 v23, 32, v20
    ds_read_b128 v[228:231], v23
    ds_read_b64_tr_b16 v[76:77], v41 offset:49152
    ds_read_b64_tr_b16 v[78:79], v41 offset:49664
    s_waitcnt lgkmcnt(9)
    v_mfma_f32_32x32x16_bf16 v[96:111], v[68:71], v[216:219], v[96:111]
    s_add_u32 m0, s51, 114688
    s_add_u32 s3, s81, 0
    buffer_load_dwordx4 v8, s[12:15], s3 offen lds
    v_xor_b32 v22, 64, v20
    ds_read_b128 v[232:235], v22
    ds_read_b64_tr_b16 v[64:65], v42 offset:49152
    ds_read_b64_tr_b16 v[66:67], v42 offset:49664
    s_waitcnt lgkmcnt(9)
    v_mfma_f32_32x32x16_bf16 v[96:111], v[72:75], v[220:223], v[96:111]
    v_xor_b32 v23, 96, v20
    ds_read_b128 v[236:239], v23
    ds_read_b64_tr_b16 v[68:69], v43 offset:49152
    ds_read_b64_tr_b16 v[70:71], v43 offset:49664
    s_waitcnt lgkmcnt(9)
    v_mfma_f32_32x32x16_bf16 v[96:111], v[88:91], v[224:227], v[96:111]
    s_add_u32 m0, s51, 122880
    s_add_u32 s3, s81, 176128
    buffer_load_dwordx4 v8, s[12:15], s3 offen lds
    v_xor_b32 v22, 128, v20
    ds_read_b128 v[240:243], v22
    ds_read_b64_tr_b16 v[92:93], v44 offset:49152
    ds_read_b64_tr_b16 v[94:95], v44 offset:49664
    s_waitcnt lgkmcnt(9)
    v_mfma_f32_32x32x16_bf16 v[96:111], v[76:79], v[228:231], v[96:111]
    v_xor_b32 v23, 160, v20
    ds_read_b128 v[244:247], v23
    ds_read_b64_tr_b16 v[72:73], v45 offset:49152
    ds_read_b64_tr_b16 v[74:75], v45 offset:49664
    s_waitcnt lgkmcnt(9)
    v_mfma_f32_32x32x16_bf16 v[96:111], v[64:67], v[232:235], v[96:111]
    v_xor_b32 v22, 192, v20
    ds_read_b128 v[248:251], v22
    ds_read_b64_tr_b16 v[76:77], v46 offset:49152
    ds_read_b64_tr_b16 v[78:79], v46 offset:49664
    s_waitcnt lgkmcnt(9)
    v_mfma_f32_32x32x16_bf16 v[96:111], v[68:71], v[236:239], v[96:111]
    v_xor_b32 v23, 224, v20
    ds_read_b128 v[252:255], v23
    ds_read_b64_tr_b16 v[64:65], v47 offset:49152
    ds_read_b64_tr_b16 v[66:67], v47 offset:49664
    s_waitcnt lgkmcnt(9)
    v_mfma_f32_32x32x16_bf16 v[96:111], v[92:95], v[240:243], v[96:111]
    s_waitcnt lgkmcnt(6)
    v_mfma_f32_32x32x16_bf16 v[96:111], v[72:75], v[244:247], v[96:111]
    s_waitcnt lgkmcnt(3)
    v_mfma_f32_32x32x16_bf16 v[96:111], v[76:79], v[248:251], v[96:111]
    s_waitcnt lgkmcnt(0)
    v_mfma_f32_32x32x16_bf16 v[96:111], v[64:67], v[252:255], v[96:111]
    v_lshrrev_b32 v5, 5, v1
    v_and_b32 v6, 31, v1
    v_xor_b32 v6, v6, v5
    v_lshlrev_b32 v6, 4, v6
    v_lshl_add_u32 v4, v5, 18, v6
    v_dot2c_f32_bf16 v18, s55, v88
    v_dot2c_f32_bf16 v18, s55, v89
    v_dot2c_f32_bf16 v18, s55, v90
    v_dot2c_f32_bf16 v18, s55, v91
    v_dot2c_f32_bf16 v18, s55, v92
    v_dot2c_f32_bf16 v18, s55, v93
    v_dot2c_f32_bf16 v18, s55, v94
    v_dot2c_f32_bf16 v18, s55, v95
    s_nop 2
    ds_write_b32 v27, v18
    s_waitcnt vmcnt(2)
    v_xor_b32 v28, s45, v57
    v_xor_b32 v29, s45, v59
    v_or_b32 v28, v28, v29
    v_cmp_ne_u32 vcc, 0, v28
    s_nop 3
    s_cbranch_vccz L_soft_got_ln
    s_mov_b32 s61, 0
L_soft_again_ln:
    buffer_load_dwordx4 v[56:59], v14, s[16:19], s50 offen sc1
    s_waitcnt vmcnt(0)
    v_xor_b32 v28, s45, v57
    v_xor_b32 v29, s45, v59
    v_or_b32 v28, v28, v29
    v_cmp_ne_u32 vcc, 0, v28
    s_add_u32 s61, s61, 1
    s_cmp_gt_u32 s61, 20000
    s_nop 1
    s_cbranch_scc1 L_soft_got_ln
    s_cbranch_vccnz L_soft_again_ln
L_soft_got_ln:
    v_and_b32 v28, 0xffff0000, v56
    v_rcp_f32 v16, v58
    v_sub_f32 v29, v56, v28
    v_mul_f32 v62, v58, v58
    v_mul_f32 v60, 0xc0135761, v58
    v_cvt_pk_bf16_f32 v48, -v28, -v28
    v_cvt_pk_bf16_f32 v49, -v29, 0
    v_mul_f32 v62, v62, v58
    v_mul_f32 v62, 0xbdd2d3e8, v62
    s_waitcnt vmcnt(3) lgkmcnt(0)
    s_barrier
    ds_read_b128 v[32:35], v37
    ds_read_b64_tr_b16 v[88:89], v40 offset:0
    ds_read_b64_tr_b16 v[90:91], v40 offset:512
    ds_read_b64_tr_b16 v[68:69], v41 offset:0
    ds_read_b64_tr_b16 v[70:71], v41 offset:512
    ds_read_b64_tr_b16 v[72:73], v42 offset:0
    ds_read_b64_tr_b16 v[74:75], v42 offset:512
    s_waitcnt lgkmcnt(6)
    v_add_f32 v32, v32, v33
    v_add_f32 v34, v34, v35
    v_add_f32 v32, v32, v34
    v_and_b32 v33, 0xffff0000, v32
    v_sub_f32 v34, v32, v33
    v_cvt_pk_bf16_f32 v52, v33, v34
    v_cvt_pk_bf16_f32 v53, v33, 0
    s_nop 1
    v_mfma_f32_32x32x16_bf16 v[96:111], v[52:55], v[48:51], v[96:111]
    s_nop 11
    v_pk_mul_f32 v[28:29], v[96:97], v[96:97]
    v_pk_mul_f32 v[30:31], v[98:99], v[98:99]
    v_pk_mul_f32 v[32:33], v[100:101], v[100:101]
    s_add_u32 m0, s51, 131072
    s_add_u32 s3, s82, 0
    buffer_load_dwordx4 v8, s[12:15], s3 offen lds
    v_pk_mul_f32 v[34:35], v[102:103], v[102:103]
    v_pk_fma_f32 v[28:29], v[28:29], v[62:63], v[60:61] op_sel_hi:[1,0,0]
    v_pk_fma_f32 v[30:31], v[30:31], v[62:63], v[60:61] op_sel_hi:[1,0,0]
    v_pk_fma_f32 v[32:33], v[32:33], v[62:63], v[60:61] op_sel_hi:[1,0,0]
    v_pk_fma_f32 v[34:35], v[34:35], v[62:63], v[60:61] op_sel_hi:[1,0,0]
    v_pk_mul_f32 v[28:29], v[28:29], v[96:97]
    v_pk_mul_f32 v[30:31], v[30:31], v[98:99]
    v_pk_mul_f32 v[32:33], v[32:33], v[100:101]
    v_pk_mul_f32 v[34:35], v[34:35], v[102:103]
    v_exp_f32 v28, v28
    v_exp_f32 v29, v29
    v_exp_f32 v30, v30
    v_exp_f32 v31, v31
    v_exp_f32 v32, v32
    v_exp_f32 v33, v33
    v_exp_f32 v34, v34
    s_add_u32 m0, s51, 139264
    s_add_u32 s3, s82, 176128
    buffer_load_dwordx4 v8, s[12:15], s3 offen lds
    v_exp_f32 v35, v35
    v_pk_fma_f32 v[28:29], v[28:29], v[16:17], v[16:17] op_sel_hi:[1,0,0]
    v_pk_fma_f32 v[30:31], v[30:31], v[16:17], v[16:17] op_sel_hi:[1,0,0]
    v_pk_fma_f32 v[32:33], v[32:33], v[16:17], v[16:17] op_sel_hi:[1,0,0]
    v_pk_fma_f32 v[34:35], v[34:35], v[16:17], v[16:17] op_sel_hi:[1,0,0]
    v_rcp_f32 v28, v28
    v_rcp_f32 v29, v29
    v_rcp_f32 v30, v30
    v_rcp_f32 v31, v31
    v_rcp_f32 v32, v32
    v_rcp_f32 v33, v33
    v_rcp_f32 v34, v34
    v_rcp_f32 v35, v35
    v_pk_mul_f32 v[96:97], v[96:97], v[28:29]
    v_pk_mul_f32 v[98:99], v[98:99], v[30:31]
    v_pk_mul_f32 v[100:101], v[100:101], v[32:33]
    s_add_u32 m0, s51, 147456
    s_add_u32 s3, s83, 0
    buffer_load_dwordx4 v8, s[12:15], s3 offen lds
    v_pk_mul_f32 v[102:103], v[102:103], v[34:35]
    v_pk_mul_f32 v[28:29], v[104:105], v[104:105]
    v_pk_mul_f32 v[30:31], v[106:107], v[106:107]
    v_pk_mul_f32 v[32:33], v[108:109], v[108:109]
    v_pk_mul_f32 v[34:35], v[110:111], v[110:111]
    v_pk_fma_f32 v[28:29], v[28:29], v[62:63], v[60:61] op_sel_hi:[1,0,0]
    v_pk_fma_f32 v[30:31], v[30:31], v[62:63], v[60:61] op_sel_hi:[1,0,0]
    v_pk_fma_f32 v[32:33], v[32:33], v[62:63], v[60:61] op_sel_hi:[1,0,0]
    v_pk_fma_f32 v[34:35], v[34:35], v[62:63], v[60:61] op_sel_hi:[1,0,0]
    v_pk_mul_f32 v[28:29], v[28:29], v[104:105]
    v_pk_mul_f32 v[30:31], v[30:31], v[106:107]
    v_pk_mul_f32 v[32:33], v[32:33], v[108:109]
    v_pk_mul_f32 v[34:35], v[34:35], v[110:111]
    v_exp_f32 v28, v28
    v_exp_f32 v29, v29
    v_exp_f32 v30, v30
    s_add_u32 m0, s51, 155648
    s_add_u32 s3, s83, 176128
    buffer_load_dwordx4 v8, s[12:15], s3 offen lds
    v_exp_f32 v31, v31
    v_exp_f32 v32, v32
    v_exp_f32 v33, v33
    v_exp_f32 v34, v34
    v_exp_f32 v35, v35
    v_pk_fma_f32 v[28:29], v[28:29], v[16:17], v[16:17] op_sel_hi:[1,0,0]
    v_pk_fma_f32 v[30:31], v[30:31], v[16:17], v[16:17] op_sel_hi:[1,0,0]
    v_pk_fma_f32 v[32:33], v[32:33], v[16:17], v[16:17] op_sel_hi:[1,0,0]
    v_pk_fma_f32 v[34:35], v[34:35], v[16:17], v[16:17] op_sel_hi:[1,0,0]
    v_rcp_f32 v28, v28
    v_rcp_f32 v29, v29
    v_rcp_f32 v30, v30
    v_rcp_f32 v31, v31
    v_rcp_f32 v32, v32
    v_rcp_f32 v33, v33
    v_rcp_f32 v34, v34
    s_xor_b32 s7, s72, 0
    s_lshr_b32 s79, s7, 1
    s_lshl_b32 s79, s79, 12
    s_and_b32 s7, s7, 1
    s_lshl_b32 s7, s7, 22
    s_add_u32 s79, s79, s7
    s_add_u32 s79, s79, s69
    s_add_u32 m0, s70, 0
    s_add_u32 s7, s79, 0
    buffer_load_dwordx4 v4, s[20:23], s7 offen lds
    v_rcp_f32 v35, v35
    v_pk_mul_f32 v[104:105], v[104:105], v[28:29]
    v_pk_mul_f32 v[106:107], v[106:107], v[30:31]
    v_pk_mul_f32 v[108:109], v[108:109], v[32:33]
    v_pk_mul_f32 v[110:111], v[110:111], v[34:35]
    v_pk_add_f32 v[28:29], v[96:97], v[98:99]
    v_pk_mul_f32 v[30:31], v[96:97], v[96:97]
    v_pk_mul_f32 v[34:35], v[98:99], v[98:99]
    v_pk_add_f32 v[32:33], v[100:101], v[102:103]
    v_pk_fma_f32 v[30:31], v[100:101], v[100:101], v[30:31]
    v_pk_fma_f32 v[34:35], v[102:103], v[102:103], v[34:35]
    v_pk_fma_f32 v[30:31], v[104:105], v[104:105], v[30:31]
    v_pk_add_f32 v[28:29], v[28:29], v[104:105]
    v_pk_fma_f32 v[34:35], v[106:107], v[106:107], v[34:35]
    v_pk_add_f32 v[32:33], v[32:33], v[106:107]
    v_pk_fma_f32 v[30:31], v[108:109], v[108:109], v[30:31]
    s_add_u32 m0, s70, 1056
    s_add_u32 s7, s79, 524288
    buffer_load_dwordx4 v4, s[20:23], s7 offen lds
    v_pk_add_f32 v[28:29], v[28:29], v[108:109]
    v_pk_fma_f32 v[34:35], v[110:111], v[110:111], v[34:35]
    v_pk_add_f32 v[32:33], v[32:33], v[110:111]
    v_pk_add_f32 v[28:29], v[28:29], v[32:33]
    v_pk_add_f32 v[30:31], v[30:31], v[34:35]
    v_add_f32 v28, v28, v29
    v_add_f32 v29, v30, v31
    v_mov_b32 v30, v28
    v_mov_b32 v31, v29
    s_nop 0
    v_permlane32_swap_b32 v28, v30
    v_permlane32_swap_b32 v29, v31
    v_pk_add_f32 v[28:29], v[28:29], v[30:31]
    ds_write_b64 v25, v[28:29]
    s_waitcnt lgkmcnt(0)
    s_barrier
    ds_read_b128 v[28:31], v24
    ds_read_b64_tr_b16 v[76:77], v43 offset:0
    ds_read_b64_tr_b16 v[78:79], v43 offset:512
    s_waitcnt lgkmcnt(8)
    v_mfma_f32_32x32x16_bf16 v[112:127], v[88:91], v[128:131], 0
    ds_read_b64_tr_b16 v[92:93], v44 offset:0
    ds_read_b64_tr_b16 v[94:95], v44 offset:512
    s_waitcnt lgkmcnt(8)
    v_mfma_f32_32x32x16_bf16 v[112:127], v[68:71], v[132:135], v[112:127]
    s_waitcnt lgkmcnt(4)
    v_add_f32 v28, v28, v30
    v_add_f32 v30, v29, v31
    v_mov_b32 v29, s45
    v_mov_b32 v31, s45
    ds_read_b64_tr_b16 v[64:65], v45 offset:0
    ds_read_b64_tr_b16 v[66:67], v45 offset:512
    s_waitcnt lgkmcnt(8)
    v_mfma_f32_32x32x16_bf16 v[112:127], v[72:75], v[136:139], v[112:127]
    s_lshl_b32 s3, s47, 11
    s_add_u32 s3, s3, s56
    s_lshl_b32 s4, s49, 30
    s_add_u32 s3, s3, s4
    buffer_store_dwordx4 v[28:31], v13, s[16:19], s3 offen sc1
    ds_read_b64_tr_b16 v[68:69], v46 offset:0
    ds_read_b64_tr_b16 v[70:71], v46 offset:512
    s_waitcnt lgkmcnt(6)
    v_mfma_f32_32x32x16_bf16 v[112:127], v[76:79], v[140:143], v[112:127]
    s_lshl_b32 s5, s44, 11
    s_add_u32 s5, s5, 79872
    v_bfe_u32 v20, v10, 1, 2
    v_lshlrev_b32 v20, 4, v20
    ds_read_b64_tr_b16 v[72:73], v47 offset:0
    ds_read_b64_tr_b16 v[74:75], v47 offset:512
    s_waitcnt lgkmcnt(6)
    v_mfma_f32_32x32x16_bf16 v[112:127], v[92:95], v[144:147], v[112:127]
    s_add_u32 m0, s70, 2112
    s_add_u32 s7, s79, 1048576
    buffer_load_dwordx4 v4, s[20:23], s7 offen lds
    v_lshl_add_u32 v20, v11, 3, v20
    v_lshl_add_u32 v20, v10, 6, v20
    v_add_u32 v20, s5, v20
    v_xor_b32 v12, 16, v20
    v_dot2c_f32_bf16 v19, s55, v88
    v_dot2c_f32_bf16 v19, s55, v89
    v_dot2c_f32_bf16 v19, s55, v90
    v_dot2c_f32_bf16 v19, s55, v91
    v_dot2c_f32_bf16 v19, s55, v92
    v_dot2c_f32_bf16 v19, s55, v93
    v_dot2c_f32_bf16 v19, s55, v94
    v_dot2c_f32_bf16 v19, s55, v95
    s_waitcnt vmcnt(8)
    s_barrier
    ds_read_b64_tr_b16 v[88:89], v40 offset:16384
    ds_read_b64_tr_b16 v[90:91], v40 offset:16896
    s_waitcnt lgkmcnt(6)
    v_mfma_f32_32x32x16_bf16 v[112:127], v[64:67], v[148:151], v[112:127]
    v_xor_b32 v14, 32, v20
    v_xor_b32 v15, 48, v20
    v_lshrrev_b32 v22, 2, v1
    v_lshrrev_b32 v23, 3, v1
    ds_read_b64_tr_b16 v[76:77], v41 offset:16384
    ds_read_b64_tr_b16 v[78:79], v41 offset:16896
    s_waitcnt lgkmcnt(6)
    v_mfma_f32_32x32x16_bf16 v[112:127], v[68:71], v[152:155], v[112:127]
    v_xor_b32 v23, v23, v1
    v_and_b32 v23, 3, v23
    v_lshlrev_b32 v23, 4, v23
    v_lshl_add_u32 v23, v22, 6, v23
    ds_read_b64_tr_b16 v[64:65], v42 offset:16384
    ds_read_b64_tr_b16 v[66:67], v42 offset:16896
    s_waitcnt lgkmcnt(6)
    v_mfma_f32_32x32x16_bf16 v[112:127], v[72:75], v[156:159], v[112:127]
    v_add_u32 v23, s5, v23
    v_and_b32 v26, 3, v22
    v_lshrrev_b32 v36, 1, v22
    v_and_or_b32 v26, v36, 4, v26
    ds_read_b64_tr_b16 v[68:69], v43 offset:16384
    ds_read_b64_tr_b16 v[70:71], v43 offset:16896
    s_waitcnt lgkmcnt(6)
    v_mfma_f32_32x32x16_bf16 v[112:127], v[88:91], v[160:163], v[112:127]
    s_add_u32 m0, s70, 3168
    s_add_u32 s7, s79, 1572864
    buffer_load_dwordx4 v4, s[20:23], s7 offen lds
    v_lshlrev_b32 v36, 1, v22
    v_and_or_b32 v26, v36, 8, v26
    v_mul_u32_u24 v26, 1408, v26
    v_and_b32 v36, 3, v1
    ds_read_b64_tr_b16 v[92:93], v44 offset:16384
    ds_read_b64_tr_b16 v[94:95], v44 offset:16896
    s_waitcnt lgkmcnt(6)
    v_mfma_f32_32x32x16_bf16 v[112:127], v[76:79], v[164:167], v[112:127]
    v_lshl_add_u32 v26, v36, 4, v26
    v_lshrrev_b32 v22, 4, v10
    v_lshlrev_b32 v22, 16, v22
    v_and_b32 v36, 15, v1
    ds_read_b64_tr_b16 v[72:73], v45 offset:16384
    ds_read_b64_tr_b16 v[74:75], v45 offset:16896
    s_waitcnt lgkmcnt(6)
    v_mfma_f32_32x32x16_bf16 v[112:127], v[64:67], v[168:171], v[112:127]
    v_lshl_add_u32 v36, v11, 4, v36
    v_lshl_add_u32 v22, v36, 4, v22
    s_lshl_b32 s6, s46, 2
    s_add_u32 s6, s6, s48
    ds_read_b64_tr_b16 v[76:77], v46 offset:16384
    ds_read_b64_tr_b16 v[78:79], v46 offset:16896
    s_waitcnt lgkmcnt(6)
    v_mfma_f32_32x32x16_bf16 v[112:127], v[68:71], v[172:175], v[112:127]
    s_mul_i32 s57, s6, 45056
    s_lshl_b32 s6, s6, 10
    s_lshl_b32 s58, s47, 2
    s_lshl_b32 s5, s49, 1
    ds_read_b64_tr_b16 v[64:65], v47 offset:16384
    ds_read_b64_tr_b16 v[66:67], v47 offset:16896
    s_waitcnt lgkmcnt(6)
    v_mfma_f32_32x32x16_bf16 v[112:127], v[92:95], v[176:179], v[112:127]
    s_add_u32 m0, s70, 4224
    s_add_u32 s7, s79, 2097152
    buffer_load_dwordx4 v4, s[20:23], s7 offen lds
    s_add_u32 s58, s58, s5
    s_lshl_b32 s58, s58, 16
    s_add_u32 s58, s58, s6
    s_add_u32 s58, s58, 3145728
    v_dot2c_f32_bf16 v19, s55, v88
    v_dot2c_f32_bf16 v19, s55, v89
    v_dot2c_f32_bf16 v19, s55, v90
    v_dot2c_f32_bf16 v19, s55, v91
    v_dot2c_f32_bf16 v19, s55, v92
    v_dot2c_f32_bf16 v19, s55, v93
    v_dot2c_f32_bf16 v19, s55, v94
    v_dot2c_f32_bf16 v19, s55, v95
    s_waitcnt vmcnt(8)
    s_barrier
    ds_read_b64_tr_b16 v[88:89], v40 offset:32768
    ds_read_b64_tr_b16 v[90:91], v40 offset:33280
    s_waitcnt lgkmcnt(6)
    v_mfma_f32_32x32x16_bf16 v[112:127], v[72:75], v[180:183], v[112:127]
    s_lshl_b32 s5, s47, 7
    s_add_u32 s57, s57, s5
    s_lshl_b32 s5, s49, 6
    s_add_u32 s57, s57, s5
    ds_read_b64_tr_b16 v[68:69], v41 offset:32768
    ds_read_b64_tr_b16 v[70:71], v41 offset:33280
    s_waitcnt lgkmcnt(6)
    v_mfma_f32_32x32x16_bf16 v[112:127], v[76:79], v[184:187], v[112:127]
    s_add_u32 s57, s57, 0
    s_add_u32 s54, s57, 22528
    s_mov_b32 s59, 0x07060302
    v_bfe_u32 v5, v1, 1, 3
    ds_read_b64_tr_b16 v[72:73], v42 offset:32768
    ds_read_b64_tr_b16 v[74:75], v42 offset:33280
    s_waitcnt lgkmcnt(6)
    v_mfma_f32_32x32x16_bf16 v[112:127], v[64:67], v[188:191], v[112:127]
    s_add_u32 m0, s70, 5280
    s_add_u32 s7, s79, 2621440
    buffer_load_dwordx4 v4, s[20:23], s7 offen lds
    v_mul_u32_u24 v5, 1056, v5
    v_and_b32 v2, 1, v1
    v_lshl_add_u32 v5, v2, 9, v5
    v_lshrrev_b32 v6, 4, v1
    ds_read_b64_tr_b16 v[76:77], v43 offset:32768
    ds_read_b64_tr_b16 v[78:79], v43 offset:33280
    s_waitcnt lgkmcnt(6)
    v_mfma_f32_32x32x16_bf16 v[112:127], v[88:91], v[192:195], v[112:127]
    v_xor_b32 v6, v6, v2
    v_lshl_add_u32 v5, v6, 4, v5
    v_add_u32 v5, s70, v5
    v_add_u32 v6, 96256, v5
    ds_read_b64_tr_b16 v[92:93], v44 offset:32768
    ds_read_b64_tr_b16 v[94:95], v44 offset:33280
    s_waitcnt lgkmcnt(6)
    v_mfma_f32_32x32x16_bf16 v[112:127], v[68:71], v[196:199], v[112:127]
    s_add_u32 s3, s56, 0
    buffer_load_dwordx4 v[128:131], v21, s[16:19], s3 offen sc1
    ds_read_b64_tr_b16 v[64:65], v45 offset:32768
    ds_read_b64_tr_b16 v[66:67], v45 offset:33280
    s_waitcnt lgkmcnt(6)
    v_mfma_f32_32x32x16_bf16 v[112:127], v[72:75], v[200:203], v[112:127]
    ds_read_b64_tr_b16 v[68:69], v46 offset:32768
    ds_read_b64_tr_b16 v[70:71], v46 offset:33280
    s_waitcnt lgkmcnt(6)
    v_mfma_f32_32x32x16_bf16 v[112:127], v[76:79], v[204:207], v[112:127]
    s_add_u32 s3, s56, 4096
    buffer_load_dwordx4 v[132:135], v21, s[16:19], s3 offen sc1
    ds_read_b64_tr_b16 v[72:73], v47 offset:32768
    ds_read_b64_tr_b16 v[74:75], v47 offset:33280
    s_waitcnt lgkmcnt(6)
    v_mfma_f32_32x32x16_bf16 v[112:127], v[92:95], v[208:211], v[112:127]
    v_dot2c_f32_bf16 v19, s55, v88
    v_dot2c_f32_bf16 v19, s55, v89
    v_dot2c_f32_bf16 v19, s55, v90
    v_dot2c_f32_bf16 v19, s55, v91
    v_dot2c_f32_bf16 v19, s55, v92
    v_dot2c_f32_bf16 v19, s55, v93
    v_dot2c_f32_bf16 v19, s55, v94
    v_dot2c_f32_bf16 v19, s55, v95
    s_waitcnt vmcnt(9)
    s_barrier
    ds_read_b64_tr_b16 v[88:89], v40 offset:49152
    ds_read_b64_tr_b16 v[90:91], v40 offset:49664
    s_waitcnt lgkmcnt(6)
    v_mfma_f32_32x32x16_bf16 v[112:127], v[64:67], v[212:215], v[112:127]
    s_add_u32 s3, s56, 8192
    buffer_load_dwordx4 v[136:139], v21, s[16:19], s3 offen sc1
    ds_read_b64_tr_b16 v[92:93], v44 offset:49152
    ds_read_b64_tr_b16 v[94:95], v44 offset:49664
    s_waitcnt lgkmcnt(6)
    v_mfma_f32_32x32x16_bf16 v[112:127], v[68:71], v[216:219], v[112:127]
    ds_read_b64_tr_b16 v[76:77], v41 offset:49152
    ds_read_b64_tr_b16 v[78:79], v41 offset:49664
    s_waitcnt lgkmcnt(6)
    v_mfma_f32_32x32x16_bf16 v[112:127], v[72:75], v[220:223], v[112:127]
    s_add_u32 s3, s56, 12288
    buffer_load_dwordx4 v[140:143], v21, s[16:19], s3 offen sc1
    ds_read_b64_tr_b16 v[64:65], v45 offset:49152
    ds_read_b64_tr_b16 v[66:67], v45 offset:49664
    s_waitcnt lgkmcnt(6)
    v_mfma_f32_32x32x16_bf16 v[112:127], v[88:91], v[224:227], v[112:127]
    ds_read_b64_tr_b16 v[68:69], v42 offset:49152
    ds_read_b64_tr_b16 v[70:71], v42 offset:49664
    s_waitcnt lgkmcnt(6)
    v_mfma_f32_32x32x16_bf16 v[112:127], v[92:95], v[240:243], v[112:127]
    s_add_u32 s3, s56, 16384
    buffer_load_dwordx4 v[144:147], v21, s[16:19], s3 offen sc1
    v_dot2c_f32_bf16 v19, s55, v88
    v_dot2c_f32_bf16 v19, s55, v89
    v_dot2c_f32_bf16 v19, s55, v90
    v_dot2c_f32_bf16 v19, s55, v91
    v_dot2c_f32_bf16 v19, s55, v92
    v_dot2c_f32_bf16 v19, s55, v93
    v_dot2c_f32_bf16 v19, s55, v94
    v_dot2c_f32_bf16 v19, s55, v95
    s_nop 2
    ds_write_b32 v27, v19 offset:2048
    ds_read_b64_tr_b16 v[72:73], v46 offset:49152
    ds_read_b64_tr_b16 v[74:75], v46 offset:49664
    s_waitcnt lgkmcnt(7)
    v_mfma_f32_32x32x16_bf16 v[112:127], v[76:79], v[228:231], v[112:127]
    ds_read_b64_tr_b16 v[76:77], v43 offset:49152
    ds_read_b64_tr_b16 v[78:79], v43 offset:49664
    s_waitcnt lgkmcnt(7)
    v_mfma_f32_32x32x16_bf16 v[112:127], v[64:67], v[244:247], v[112:127]
    s_add_u32 s3, s56, 20480
    buffer_load_dwordx4 v[148:151], v9, s[16:19], s3 offen sc1
    s_waitcnt lgkmcnt(4)
    s_barrier
    ds_read_b128 v[32:35], v37 offset:2048
    ds_read_b64_tr_b16 v[64:65], v47 offset:49152
    ds_read_b64_tr_b16 v[66:67], v47 offset:49664
    s_waitcnt lgkmcnt(8)
    v_mfma_f32_32x32x16_bf16 v[112:127], v[68:71], v[232:235], v[112:127]
    s_add_u32 m0, s70, 6336
    s_add_u32 s7, s79, 3145728
    buffer_load_dwordx4 v4, s[20:23], s7 offen lds
    s_waitcnt lgkmcnt(5)
    v_mfma_f32_32x32x16_bf16 v[112:127], v[72:75], v[248:251], v[112:127]
    s_waitcnt lgkmcnt(3)
    v_mfma_f32_32x32x16_bf16 v[112:127], v[76:79], v[236:239], v[112:127]
    s_waitcnt lgkmcnt(2)
    v_add_f32 v32, v32, v33
    v_add_f32 v34, v34, v35
    v_add_f32 v32, v32, v34
    v_and_b32 v33, 0xffff0000, v32
    v_sub_f32 v34, v32, v33
    v_cvt_pk_bf16_f32 v52, v33, v34
    v_cvt_pk_bf16_f32 v53, v33, 0
    s_nop 1
    v_mfma_f32_32x32x16_bf16 v[112:127], v[52:55], v[48:51], v[112:127]
    s_waitcnt lgkmcnt(0)
    v_mfma_f32_32x32x16_bf16 v[112:127], v[64:67], v[252:255], v[112:127]
    s_add_u32 m0, s70, 7392
    s_add_u32 s7, s79, 3670016
    buffer_load_dwordx4 v4, s[20:23], s7 offen lds
    s_barrier
    s_nop 7
    v_pk_mul_f32 v[28:29], v[112:113], v[112:113]
    v_pk_mul_f32 v[30:31], v[114:115], v[114:115]
    v_pk_mul_f32 v[32:33], v[116:117], v[116:117]
    v_pk_mul_f32 v[34:35], v[118:119], v[118:119]
    s_xor_b32 s7, s72, 1
    s_lshr_b32 s79, s7, 1
    s_lshl_b32 s79, s79, 12
    s_and_b32 s7, s7, 1
    s_lshl_b32 s7, s7, 22
    s_add_u32 s79, s79, s7
    s_add_u32 s79, s79, s69
    s_add_u32 m0, s70, 96256
    s_add_u32 s7, s79, 0
    buffer_load_dwordx4 v4, s[20:23], s7 offen lds
    v_pk_fma_f32 v[28:29], v[28:29], v[62:63], v[60:61] op_sel_hi:[1,0,0]
    v_pk_fma_f32 v[30:31], v[30:31], v[62:63], v[60:61] op_sel_hi:[1,0,0]
    v_pk_fma_f32 v[32:33], v[32:33], v[62:63], v[60:61] op_sel_hi:[1,0,0]
    v_pk_fma_f32 v[34:35], v[34:35], v[62:63], v[60:61] op_sel_hi:[1,0,0]
    v_pk_mul_f32 v[28:29], v[28:29], v[112:113]
    v_pk_mul_f32 v[30:31], v[30:31], v[114:115]
    v_pk_mul_f32 v[32:33], v[32:33], v[116:117]
    v_pk_mul_f32 v[34:35], v[34:35], v[118:119]
    v_exp_f32 v28, v28
    s_add_u32 m0, s70, 97312
    s_add_u32 s7, s79, 524288
    buffer_load_dwordx4 v4, s[20:23], s7 offen lds
    v_exp_f32 v29, v29
    v_exp_f32 v30, v30
    v_exp_f32 v31, v31
    v_exp_f32 v32, v32
    v_exp_f32 v33, v33
    v_exp_f32 v34, v34
    v_exp_f32 v35, v35
    v_pk_fma_f32 v[28:29], v[28:29], v[16:17], v[16:17] op_sel_hi:[1,0,0]
    v_pk_fma_f32 v[30:31], v[30:31], v[16:17], v[16:17] op_sel_hi:[1,0,0]
    s_add_u32 m0, s70, 98368
    s_add_u32 s7, s79, 1048576
    buffer_load_dwordx4 v4, s[20:23], s7 offen lds
    v_pk_fma_f32 v[32:33], v[32:33], v[16:17], v[16:17] op_sel_hi:[1,0,0]
    v_pk_fma_f32 v[34:35], v[34:35], v[16:17], v[16:17] op_sel_hi:[1,0,0]
    v_rcp_f32 v28, v28
    v_rcp_f32 v29, v29
    v_rcp_f32 v30, v30
    v_rcp_f32 v31, v31
    v_rcp_f32 v32, v32
    v_rcp_f32 v33, v33
    v_rcp_f32 v34, v34
    s_add_u32 m0, s70, 99424
    s_add_u32 s7, s79, 1572864
    buffer_load_dwordx4 v4, s[20:23], s7 offen lds
    v_rcp_f32 v35, v35
    v_pk_mul_f32 v[112:113], v[112:113], v[28:29]
    v_pk_mul_f32 v[114:115], v[114:115], v[30:31]
    v_pk_mul_f32 v[116:117], v[116:117], v[32:33]
    v_pk_mul_f32 v[118:119], v[118:119], v[34:35]
    v_pk_mul_f32 v[28:29], v[120:121], v[120:121]
    v_pk_mul_f32 v[30:31], v[122:123], v[122:123]
    v_pk_mul_f32 v[32:33], v[124:125], v[124:125]
    v_pk_mul_f32 v[34:35], v[126:127], v[126:127]
    s_add_u32 m0, s70, 100480
    s_add_u32 s7, s79, 2097152
    buffer_load_dwordx4 v4, s[20:23], s7 offen lds
    v_pk_fma_f32 v[28:29], v[28:29], v[62:63], v[60:61] op_sel_hi:[1,0,0]
    v_pk_fma_f32 v[30:31], v[30:31], v[62:63], v[60:61] op_sel_hi:[1,0,0]
    v_pk_fma_f32 v[32:33], v[32:33], v[62:63], v[60:61] op_sel_hi:[1,0,0]
    v_pk_fma_f32 v[34:35], v[34:35], v[62:63], v[60:61] op_sel_hi:[1,0,0]
    v_pk_mul_f32 v[28:29], v[28:29], v[120:121]
    v_pk_mul_f32 v[30:31], v[30:31], v[122:123]
    v_pk_mul_f32 v[32:33], v[32:33], v[124:125]
    v_pk_mul_f32 v[34:35], v[34:35], v[126:127]
    v_exp_f32 v28, v28
    s_add_u32 m0, s70, 101536
    s_add_u32 s7, s79, 2621440
    buffer_load_dwordx4 v4, s[20:23], s7 offen lds
    v_exp_f32 v29, v29
    v_exp_f32 v30, v30
    v_exp_f32 v31, v31
    v_exp_f32 v32, v32
    v_exp_f32 v33, v33
    v_exp_f32 v34, v34
    v_exp_f32 v35, v35
    v_pk_fma_f32 v[28:29], v[28:29], v[16:17], v[16:17] op_sel_hi:[1,0,0]
    v_pk_fma_f32 v[30:31], v[30:31], v[16:17], v[16:17] op_sel_hi:[1,0,0]
    s_add_u32 m0, s70, 102592
    s_add_u32 s7, s79, 3145728
    buffer_load_dwordx4 v4, s[20:23], s7 offen lds
    v_pk_fma_f32 v[32:33], v[32:33], v[16:17], v[16:17] op_sel_hi:[1,0,0]
    v_pk_fma_f32 v[34:35], v[34:35], v[16:17], v[16:17] op_sel_hi:[1,0,0]
    v_rcp_f32 v28, v28
    v_rcp_f32 v29, v29
    v_rcp_f32 v30, v30
    v_rcp_f32 v31, v31
    v_rcp_f32 v32, v32
    v_rcp_f32 v33, v33
    v_rcp_f32 v34, v34
    s_add_u32 m0, s70, 103648
    s_add_u32 s7, s79, 3670016
    buffer_load_dwordx4 v4, s[20:23], s7 offen lds
    v_rcp_f32 v35, v35
    v_pk_mul_f32 v[120:121], v[120:121], v[28:29]
    v_pk_mul_f32 v[122:123], v[122:123], v[30:31]
    v_pk_mul_f32 v[124:125], v[124:125], v[32:33]
    v_pk_mul_f32 v[126:127], v[126:127], v[34:35]
    v_cvt_pk_bf16_f32 v64, v112, v113
    v_cvt_pk_bf16_f32 v65, v114, v115
    ds_write_b64 v20, v[64:65]
    v_cvt_pk_bf16_f32 v66, v116, v117
    v_cvt_pk_bf16_f32 v67, v118, v119
    ds_write_b64 v12, v[66:67]
    v_cvt_pk_bf16_f32 v68, v120, v121
    v_cvt_pk_bf16_f32 v69, v122, v123
    ds_write_b64 v14, v[68:69]
    v_cvt_pk_bf16_f32 v70, v124, v125
    v_cvt_pk_bf16_f32 v71, v126, v127
    ds_write_b64 v15, v[70:71]
    s_waitcnt vmcnt(10)
    v_xor_b32 v28, s45, v129
    v_xor_b32 v29, s45, v131
    v_xor_b32 v30, s45, v133
    v_xor_b32 v31, s45, v135
    v_or3_b32 v28, v28, v30, v31
    v_xor_b32 v30, s45, v137
    v_xor_b32 v31, s45, v139
    v_or3_b32 v28, v28, v30, v31
    v_xor_b32 v30, s45, v141
    v_xor_b32 v31, s45, v143
    v_or3_b32 v28, v28, v30, v31
    v_xor_b32 v30, s45, v145
    v_xor_b32 v31, s45, v147
    v_or3_b32 v28, v28, v30, v31
    v_xor_b32 v30, s45, v149
    v_xor_b32 v31, s45, v151
    v_or3_b32 v28, v28, v30, v31
    v_or_b32 v28, v28, v29
    v_cmp_ne_u32 vcc, 0, v28
    s_nop 3
    s_cbranch_vccz L_soft_got_st
    s_mov_b32 s61, 0
L_soft_again_st:
    s_add_u32 s3, s56, 0
    buffer_load_dwordx4 v[128:131], v21, s[16:19], s3 offen sc1
    s_add_u32 s3, s56, 4096
    buffer_load_dwordx4 v[132:135], v21, s[16:19], s3 offen sc1
    s_add_u32 s3, s56, 8192
    buffer_load_dwordx4 v[136:139], v21, s[16:19], s3 offen sc1
    s_add_u32 s3, s56, 12288
    buffer_load_dwordx4 v[140:143], v21, s[16:19], s3 offen sc1
    s_add_u32 s3, s56, 16384
    buffer_load_dwordx4 v[144:147], v21, s[16:19], s3 offen sc1
    s_add_u32 s3, s56, 20480
    buffer_load_dwordx4 v[148:151], v9, s[16:19], s3 offen sc1
    s_waitcnt vmcnt(0)
    v_xor_b32 v28, s45, v129
    v_xor_b32 v29, s45, v131
    v_xor_b32 v30, s45, v133
    v_xor_b32 v31, s45, v135
    v_or3_b32 v28, v28, v30, v31
    v_xor_b32 v30, s45, v137
    v_xor_b32 v31, s45, v139
    v_or3_b32 v28, v28, v30, v31
    v_xor_b32 v30, s45, v141
    v_xor_b32 v31, s45, v143
    v_or3_b32 v28, v28, v30, v31
    v_xor_b32 v30, s45, v145
    v_xor_b32 v31, s45, v147
    v_or3_b32 v28, v28, v30, v31
    v_xor_b32 v30, s45, v149
    v_xor_b32 v31, s45, v151
    v_or3_b32 v28, v28, v30, v31
    v_or_b32 v28, v28, v29
    v_cmp_ne_u32 vcc, 0, v28
    s_add_u32 s61, s61, 1
    s_cmp_gt_u32 s61, 20000
    s_nop 1
    s_cbranch_scc1 L_soft_got_st
    s_cbranch_vccnz L_soft_again_st
L_soft_got_st:
    s_waitcnt lgkmcnt(0)
    ds_read_b128 v[72:75], v23
    ds_read_b128 v[76:79], v23 offset:1024
    v_cmp_eq_u32 vcc, 0, v11
    v_add_f32 v30, v128, v132
    v_add_f32 v31, v130, v134
    v_cndmask_b32 v28, 0, v148, vcc
    v_cndmask_b32 v29, 0, v150, vcc
    v_add_f32 v28, v28, v136
    v_add_f32 v29, v29, v138
    v_add_f32 v30, v30, v140
    v_add_f32 v31, v31, v142
    v_add_f32 v28, v28, v144
    v_add_f32 v29, v29, v146
    v_add_f32 v28, v28, v30
    v_add_f32 v29, v29, v31
    v_mov_b32 v30, v28
    v_mov_b32 v31, v29
    s_waitcnt vmcnt(8)
    ds_read_b128 v[128:131], v5 offset:0
    ds_read_b128 v[132:135], v5 offset:64
    ds_read_b128 v[136:139], v5 offset:128
    ds_read_b128 v[140:143], v5 offset:192
    ds_read_b128 v[144:147], v5 offset:256
    ds_read_b128 v[148:151], v5 offset:320
    ds_read_b128 v[152:155], v5 offset:384
    ds_read_b128 v[156:159], v5 offset:448
    v_permlane32_swap_b32 v28, v30
    v_permlane32_swap_b32 v29, v31
    v_add_f32 v28, v28, v30
    v_add_f32 v29, v29, v31
    v_mul_f32 v28, 0x3abe82fa, v28
    v_mul_f32 v29, 0x3abe82fa, v29
    v_fma_f32 v29, -v28, v28, v29
    v_add_f32 v29, 0x3727c5ac, v29
    v_rsq_f32 v30, v29
    s_waitcnt lgkmcnt(8)
    buffer_store_dwordx4 v[72:75], v26, s[16:19], s57 offen sc1
    v_mul_f32 v28, -v28, v30
    buffer_store_dwordx4 v[76:79], v26, s[16:19], s54 offen sc1
    v_pk_fma_f32 v[96:97], v[96:97], v[30:31], v[28:29] op_sel_hi:[1,0,0]
    v_pk_fma_f32 v[98:99], v[98:99], v[30:31], v[28:29] op_sel_hi:[1,0,0]
    v_pk_fma_f32 v[100:101], v[100:101], v[30:31], v[28:29] op_sel_hi:[1,0,0]
    v_pk_fma_f32 v[102:103], v[102:103], v[30:31], v[28:29] op_sel_hi:[1,0,0]
    v_pk_fma_f32 v[104:105], v[104:105], v[30:31], v[28:29] op_sel_hi:[1,0,0]
    v_pk_fma_f32 v[106:107], v[106:107], v[30:31], v[28:29] op_sel_hi:[1,0,0]
    v_pk_fma_f32 v[108:109], v[108:109], v[30:31], v[28:29] op_sel_hi:[1,0,0]
    v_pk_fma_f32 v[110:111], v[110:111], v[30:31], v[28:29] op_sel_hi:[1,0,0]
    v_cvt_pk_bf16_f32 v64, v96, v97
    v_cvt_pk_bf16_f32 v65, v98, v99
    v_cvt_pk_bf16_f32 v66, v100, v101
    v_cvt_pk_bf16_f32 v67, v102, v103
    v_cvt_pk_bf16_f32 v68, v104, v105
    v_cvt_pk_bf16_f32 v69, v106, v107
    v_cvt_pk_bf16_f32 v70, v108, v109
    v_cvt_pk_bf16_f32 v71, v110, v111
    v_mfma_f32_32x32x16_bf16 v[96:111], v[64:67], v[80:83], 0
    s_nop 0
    v_mfma_f32_32x32x16_bf16 v[96:111], v[68:71], v[84:87], v[96:111]
    s_nop 11
    v_perm_b32 v64, v97, v96, s59
    v_perm_b32 v65, v99, v98, s59
    v_perm_b32 v66, v101, v100, s59
    v_perm_b32 v67, v103, v102, s59
    buffer_store_dwordx4 v[64:67], v22, s[16:19], s58 offen offset:0 sc1
    v_perm_b32 v68, v105, v104, s59
    v_perm_b32 v69, v107, v106, s59
    v_perm_b32 v70, v109, v108, s59
    v_perm_b32 v71, v111, v110, s59
    buffer_store_dwordx4 v[68:71], v22, s[16:19], s58 offen offset:512 sc1
    s_waitcnt lgkmcnt(0)
    s_barrier
L_p2:
    v_lshlrev_b32 v10, 4, v1
    v_and_b32 v12, 15, v1
    v_lshrrev_b32 v13, 4, v1
    v_cvt_f32_u32 v8, v1
    v_mul_f32 v8, 0x3c800000, v8
    v_cos_f32 v9, v8
    s_xor_b32 s7, s72, 2
    s_lshr_b32 s79, s7, 1
    s_lshl_b32 s79, s79, 12
    s_and_b32 s7, s7, 1
    s_lshl_b32 s7, s7, 22
    s_add_u32 s79, s79, s7
    s_add_u32 s79, s79, s69
    s_add_u32 m0, s70, 0
    s_add_u32 s7, s79, 0
    buffer_load_dwordx4 v4, s[20:23], s7 offen lds
    v_sin_f32 v8, v8
    v_mov_b32 v11, 67584
    v_lshl_add_u32 v14, v1, 2, v11
    v_cvt_pk_bf16_f32 v8, v9, v8
    ds_write_b32 v14, v8
    s_and_b32 s73, s44, 1
    s_lshr_b32 s74, s44, 1
    v_mul_u32_u24 v7, 65792, v13
    v_lshl_add_u32 v7, v12, 1, v7
    s_lshl_b32 s5, s74, 9
    s_add_u32 s5, s5, s67
    s_add_u32 m0, s70, 1056
    s_add_u32 s7, s79, 524288
    buffer_load_dwordx4 v4, s[20:23], s7 offen lds
    s_mul_i32 s5, s5, 514
    s_lshl_b32 s6, s68, 1
    s_add_u32 s6, s6, s73
    s_lshl_b32 s75, s6, 4
    s_add_u32 s75, s75, 1
    s_lshl_b32 s6, s75, 1
    s_add_u32 s83, s5, s6
    s_add_u32 s3, s65, 1
    s_lshl_b32 s71, s3, 16
    s_lshl_b32 s3, s44, 13
    s_add_u32 s71, s71, s3
    s_add_u32 m0, s70, 2112
    s_add_u32 s7, s79, 1048576
    buffer_load_dwordx4 v4, s[20:23], s7 offen lds
    s_add_u32 s71, s71, 3145728
    s_and_b32 s3, s64, 3
    s_mov_b32 s55, 0
    s_xor_b32 s56, s3, 0
    s_add_u32 s56, s56, 1
    s_xor_b32 s57, s3, 1
    s_add_u32 s57, s57, 1
    s_xor_b32 s58, s3, 2
    s_add_u32 s58, s58, 1
    s_xor_b32 s59, s3, 3
    s_add_u32 s59, s59, 1
    s_add_u32 m0, s70, 3168
    s_add_u32 s7, s79, 1572864
    buffer_load_dwordx4 v4, s[20:23], s7 offen lds
    s_lshl_b32 s3, s74, 6
    v_lshl_add_u32 v8, v12, 2, s3
    v_lshlrev_b32 v9, 2, v13
    v_mul_u32_u24 v9, v9, v8
    s_movk_i32 s4, 0xff
    v_mad_u32_u24 v16, v8, 0, v9
    v_mad_u32_u24 v17, v8, 1, v9
    v_mad_u32_u24 v18, v8, 2, v9
    v_mad_u32_u24 v19, v8, 3, v9
    v_mad_u32_u24 v20, v8, 16, v9
    v_mad_u32_u24 v21, v8, 17, v9
    s_add_u32 m0, s70, 4224
    s_add_u32 s7, s79, 2097152
    buffer_load_dwordx4 v4, s[20:23], s7 offen lds
    v_mad_u32_u24 v22, v8, 18, v9
    v_mad_u32_u24 v23, v8, 19, v9
    v_mad_u32_u24 v24, v8, 32, v9
    v_mad_u32_u24 v25, v8, 33, v9
    v_mad_u32_u24 v26, v8, 34, v9
    v_mad_u32_u24 v27, v8, 35, v9
    v_mad_u32_u24 v28, v8, 48, v9
    v_mad_u32_u24 v29, v8, 49, v9
    v_mad_u32_u24 v30, v8, 50, v9
    v_mad_u32_u24 v31, v8, 51, v9
    v_and_or_b32 v16, v16, s4, v11
    s_add_u32 m0, s70, 5280
    s_add_u32 s7, s79, 2621440
    buffer_load_dwordx4 v4, s[20:23], s7 offen lds
    v_and_or_b32 v17, v17, s4, v11
    v_and_or_b32 v18, v18, s4, v11
    v_and_or_b32 v19, v19, s4, v11
    v_and_or_b32 v20, v20, s4, v11
    v_and_or_b32 v21, v21, s4, v11
    v_and_or_b32 v22, v22, s4, v11
    v_and_or_b32 v23, v23, s4, v11
    v_and_or_b32 v24, v24, s4, v11
    v_and_or_b32 v25, v25, s4, v11
    v_and_or_b32 v26, v26, s4, v11
    v_and_or_b32 v27, v27, s4, v11
    s_add_u32 m0, s70, 6336
    s_add_u32 s7, s79, 3145728
    buffer_load_dwordx4 v4, s[20:23], s7 offen lds
    v_and_or_b32 v28, v28, s4, v11
    v_and_or_b32 v29, v29, s4, v11
    v_and_or_b32 v30, v30, s4, v11
    v_and_or_b32 v31, v31, s4, v11
    s_waitcnt lgkmcnt(0)
    ds_read_b32 v32, v16
    ds_read_b32 v33, v17
    ds_read_b32 v34, v18
    ds_read_b32 v35, v19
    ds_read_b32 v36, v20
    ds_read_b32 v37, v21
    s_add_u32 m0, s70, 7392
    s_add_u32 s7, s79, 3670016
    buffer_load_dwordx4 v4, s[20:23], s7 offen lds
    ds_read_b32 v38, v22
    ds_read_b32 v39, v23
    ds_read_b32 v40, v24
    ds_read_b32 v41, v25
    ds_read_b32 v42, v26
    ds_read_b32 v43, v27
    ds_read_b32 v44, v28
    ds_read_b32 v45, v29
    ds_read_b32 v46, v30
    ds_read_b32 v47, v31
    s_waitcnt vmcnt(12)
    ds_read_b128 v[160:163], v6 offset:0
    ds_read_b128 v[164:167], v6 offset:64
    ds_read_b128 v[168:171], v6 offset:128
    ds_read_b128 v[172:175], v6 offset:192
    ds_read_b128 v[176:179], v6 offset:256
    ds_read_b128 v[180:183], v6 offset:320
    ds_read_b128 v[184:187], v6 offset:384
    ds_read_b128 v[188:191], v6 offset:448
    s_waitcnt vmcnt(8)
    s_barrier
    s_cmp_lg_u32 s44, 0
    s_cbranch_scc1 L_soft_p2_a
    v_mul_u32_u24 v2, 4096, v1
    v_cmp_gt_u32 vcc, 4, v1
    v_mov_b32 v3, 0x40000000
    s_nop 0
    v_cndmask_b32 v2, v3, v2, vcc
    v_mov_b32 v3, s45
    buffer_store_dword v3, v2, s[16:19], s63 offen sc1
L_soft_p2_a:
    s_add_u32 s6, s83, 0
    buffer_load_ushort v56, v7, s[24:27], s6 offen
    buffer_load_ushort v60, v7, s[28:31], s6 offen
    s_add_u32 s6, s83, 16448
    buffer_load_ushort v57, v7, s[24:27], s6 offen
    buffer_load_ushort v61, v7, s[28:31], s6 offen
    s_add_u32 s6, s83, 32896
    buffer_load_ushort v58, v7, s[24:27], s6 offen
    buffer_load_ushort v62, v7, s[28:31], s6 offen
    s_add_u32 s6, s83, 49344
    buffer_load_ushort v59, v7, s[24:27], s6 offen
    buffer_load_ushort v63, v7, s[28:31], s6 offen
    s_and_b32 s76, s44, 3
    s_lshr_b32 s77, s44, 2
    s_lshr_b32 s3, s76, 1
    s_lshl_b32 s4, s64, 1
    s_add_u32 s3, s3, s4
    s_mul_i32 s78, s3, 44032
    s_and_b32 s4, s76, 1
    s_lshl_b32 s5, s4, 7
    s_add_u32 s78, s78, s5
    s_lshl_b32 s5, s65, 10
    s_add_u32 s78, s78, s5
    s_add_u32 s78, s78, 10485760
    s_lshl_b32 s4, s4, 10
    s_add_u32 s3, s3, s4
    s_lshl_b32 s3, s3, 1
    v_lshlrev_b32 v9, 7, v12
    buffer_load_ushort v15, v9, s[32:35], s3 offen
    s_waitcnt lgkmcnt(0)
    s_xor_b32 s7, s72, 3
    s_lshr_b32 s79, s7, 1
    s_lshl_b32 s79, s79, 12
    s_and_b32 s7, s7, 1
    s_lshl_b32 s7, s7, 22
    s_add_u32 s79, s79, s7
    s_add_u32 s79, s79, s69
    s_add_u32 m0, s70, 96256
    s_add_u32 s7, s79, 0
    buffer_load_dwordx4 v4, s[20:23], s7 offen lds
    s_add_u32 m0, s70, 97312
    s_add_u32 s7, s79, 524288
    buffer_load_dwordx4 v4, s[20:23], s7 offen lds
    s_add_u32 m0, s70, 98368
    s_add_u32 s7, s79, 1048576
    buffer_load_dwordx4 v4, s[20:23], s7 offen lds
    s_add_u32 m0, s70, 99424
    s_add_u32 s7, s79, 1572864
    buffer_load_dwordx4 v4, s[20:23], s7 offen lds
    s_add_u32 m0, s70, 100480
    s_add_u32 s7, s79, 2097152
    buffer_load_dwordx4 v4, s[20:23], s7 offen lds
    s_add_u32 m0, s70, 101536
    s_add_u32 s7, s79, 2621440
    buffer_load_dwordx4 v4, s[20:23], s7 offen lds
    s_add_u32 m0, s70, 102592
    s_add_u32 s7, s79, 3145728
    buffer_load_dwordx4 v4, s[20:23], s7 offen lds
    s_add_u32 m0, s70, 103648
    s_add_u32 s7, s79, 3670016
    buffer_load_dwordx4 v4, s[20:23], s7 offen lds
    s_bfe_u32 s3, s2, 0x20003
    s_lshl_b32 s3, s3, 12
    s_add_u32 s62, s3, 14684160
    s_lshr_b32 s3, s65, 2
    s_add_u32 s4, s65, s66
    s_lshr_b32 s4, s4, 2
    v_add_u32 v8, s3, v13
    v_min_u32 v8, s4, v8
    s_lshr_b32 s3, s68, 1
    s_add_u32 s3, s3, 11
    v_mov_b32 v9, s3
    v_cmp_eq_u32 vcc, 3, v13
    s_nop 1
    v_cndmask_b32 v8, v8, v9, vcc
    v_lshlrev_b32 v9, 2, v12
    v_lshl_add_u32 v8, v8, 8, v9
    s_lshl_b32 s3, s44, 2
    v_add_u32 v20, s3, v13
    v_xor_b32 v4, v20, v1
    v_and_b32 v4, 15, v4
    v_mul_u32_u24 v20, 90112, v20
    v_lshl_add_u32 v20, v4, 4, v20
    s_lshl_b32 s3, s66, 1
    v_cmp_gt_u32 vcc, s3, v4
    v_mov_b32 v4, 0x40000000
    s_nop 0
    v_cndmask_b32 v4, v4, v20, vcc
    s_mul_i32 s3, s64, 2816
    s_lshl_b32 s4, s65, 5
    s_add_u32 s3, s3, s4
    s_add_u32 s53, s3, 0
    s_lshl_b32 s52, s44, 10
    s_cmp_eq_u32 s66, 6
    s_cselect_b32 s54, 5, 0x4000
    s_lshl_b32 s79, s55, 16
    s_add_u32 s79, s79, s71
    s_add_u32 s80, s79, 4096
    s_lshl_b32 s4, s67, 16
    s_lshl_b32 s3, s68, 13
    s_add_u32 s4, s4, s3
    s_add_u32 s4, s4, s52
    s_add_u32 s60, s4, 6291456
    s_waitcnt vmcnt(17)
    ds_read_b128 v[192:195], v5 offset:0
    ds_read_b128 v[196:199], v5 offset:64
    ds_read_b128 v[200:203], v5 offset:128
    ds_read_b128 v[204:207], v5 offset:192
    ds_read_b128 v[208:211], v5 offset:256
    ds_read_b128 v[212:215], v5 offset:320
    ds_read_b128 v[216:219], v5 offset:384
    ds_read_b128 v[220:223], v5 offset:448
    s_waitcnt vmcnt(0)
    ds_read_b128 v[224:227], v6 offset:0
    ds_read_b128 v[228:231], v6 offset:64
    ds_read_b128 v[232:235], v6 offset:128
    ds_read_b128 v[236:239], v6 offset:192
    ds_read_b128 v[240:243], v6 offset:256
    ds_read_b128 v[244:247], v6 offset:320
    ds_read_b128 v[248:251], v6 offset:384
    ds_read_b128 v[252:255], v6 offset:448
    s_cmp_lg_u32 s44, 0
    s_cbranch_scc1 L_soft_p2_d
    s_mov_b32 s61, 0
L_soft_poll1:
    buffer_load_dword v9, v8, s[16:19], s62 offen sc1
    s_waitcnt vmcnt(0)
    v_xor_b32 v2, s45, v9
    v_cmp_ne_u32 vcc, 0, v2
    s_add_u32 s61, s61, 1
    s_cmp_gt_u32 s61, 20000
    s_nop 1
    s_cbranch_scc1 L_soft_pollx1
    s_cbranch_vccnz L_soft_poll1
L_soft_pollx1:
L_soft_p2_d:
    s_waitcnt lgkmcnt(0)
    s_barrier
    s_cmp_eq_u32 s66, 6
    s_cbranch_scc1 L_soft_p2_six
    s_lshl_b32 s81, s56, 16
    s_add_u32 s81, s81, s71
    s_add_u32 s82, s81, 4096
    s_add_u32 m0, s52, 98304
    s_nop 0
    buffer_load_dwordx4 v10, s[16:19], s60 offen lds
    s_lshl_b32 s3, s73, 6
    s_add_u32 s3, s3, 98304
    buffer_load_dwordx4 v[64:67], v10, s[16:19], s79 offen offset:0
    v_lshlrev_b32 v8, 9, v13
    v_lshl_add_u32 v8, v12, 2, v8
    v_add_u32 v8, s3, v8
    buffer_load_dwordx4 v[68:71], v10, s[16:19], s79 offen offset:1024
    v_add_u32 v9, s75, v12
    v_cmp_eq_u32 vcc, 0x100, v9
    v_mov_b32 v14, 0x36000000
    buffer_load_dwordx4 v[72:75], v10, s[16:19], s79 offen offset:2048
    v_mov_b32 v9, 0x35800000
    v_cndmask_b32 v14, v14, v9, vcc
    v_lshlrev_b32 v56, 16, v56
    buffer_load_dwordx4 v[76:79], v10, s[16:19], s79 offen offset:3072
    v_mul_f32 v56, v14, v56
    v_lshlrev_b32 v57, 16, v57
    v_mul_f32 v57, v14, v57
    buffer_load_dwordx4 v[80:83], v10, s[16:19], s80 offen offset:0
    v_lshlrev_b32 v58, 16, v58
    v_mul_f32 v58, v14, v58
    v_lshlrev_b32 v59, 16, v59
    buffer_load_dwordx4 v[84:87], v10, s[16:19], s80 offen offset:1024
    v_mul_f32 v59, v14, v59
    v_lshlrev_b32 v60, 16, v60
    v_mul_f32 v60, v14, v60
    buffer_load_dwordx4 v[88:91], v10, s[16:19], s80 offen offset:2048
    v_lshlrev_b32 v61, 16, v61
    v_mul_f32 v61, v14, v61
    v_lshlrev_b32 v62, 16, v62
    buffer_load_dwordx4 v[92:95], v10, s[16:19], s80 offen offset:3072
    v_mul_f32 v62, v14, v62
    v_lshlrev_b32 v63, 16, v63
    v_mul_f32 v63, v14, v63
    s_waitcnt vmcnt(8)
    s_barrier
    s_add_u32 m0, s52, 65536
    s_add_u32 s7, s53, 0
    buffer_load_dwordx4 v4, s[16:19], s7 offen lds
    s_add_u32 m0, s52, 73728
    s_add_u32 s7, s53, 1408
    buffer_load_dwordx4 v4, s[16:19], s7 offen lds
    ds_read_b32 v16, v8 offset:0
    ds_read_b32 v17, v8 offset:128
    ds_read_b32 v18, v8 offset:256
    ds_read_b32 v19, v8 offset:384
    ds_read_b32 v20, v8 offset:2048
    ds_read_b32 v21, v8 offset:2176
    ds_read_b32 v22, v8 offset:2304
    ds_read_b32 v23, v8 offset:2432
    ds_read_b32 v24, v8 offset:4096
    ds_read_b32 v25, v8 offset:4224
    ds_read_b32 v26, v8 offset:4352
    ds_read_b32 v27, v8 offset:4480
    ds_read_b32 v28, v8 offset:6144
    ds_read_b32 v29, v8 offset:6272
    ds_read_b32 v30, v8 offset:6400
    ds_read_b32 v31, v8 offset:6528
    s_lshl_b32 s3, s73, 12
    s_add_u32 s3, s3, 106496
    v_add_u32 v8, s3, v10
    s_lshl_b32 s3, s74, 10
    v_add_u32 v9, s3, v8
    v_alignbit_b32 v4, v32, v32, 16
    v_alignbit_b32 v5, v33, v33, 16
    v_alignbit_b32 v6, v34, v34, 16
    v_alignbit_b32 v7, v35, v35, 16
    v_xor_b32 v4, 0x8000, v4
    v_xor_b32 v5, 0x8000, v5
    v_xor_b32 v6, 0x8000, v6
    v_xor_b32 v7, 0x8000, v7
    s_waitcnt lgkmcnt(12)
    v_mfma_f32_16x16x32_bf16 v[48:51], v[32:35], v[16:19], 0
    v_mfma_f32_16x16x32_bf16 v[52:55], v[4:7], v[16:19], 0
    v_alignbit_b32 v4, v36, v36, 16
    v_alignbit_b32 v5, v37, v37, 16
    v_alignbit_b32 v6, v38, v38, 16
    v_alignbit_b32 v7, v39, v39, 16
    v_xor_b32 v4, 0x8000, v4
    v_xor_b32 v5, 0x8000, v5
    v_xor_b32 v6, 0x8000, v6
    v_xor_b32 v7, 0x8000, v7
    s_waitcnt lgkmcnt(8)
    v_mfma_f32_16x16x32_bf16 v[48:51], v[36:39], v[20:23], v[48:51]
    v_mfma_f32_16x16x32_bf16 v[52:55], v[4:7], v[20:23], v[52:55]
    v_alignbit_b32 v4, v40, v40, 16
    v_alignbit_b32 v5, v41, v41, 16
    v_alignbit_b32 v6, v42, v42, 16
    v_alignbit_b32 v7, v43, v43, 16
    v_xor_b32 v4, 0x8000, v4
    v_xor_b32 v5, 0x8000, v5
    v_xor_b32 v6, 0x8000, v6
    v_xor_b32 v7, 0x8000, v7
    s_waitcnt lgkmcnt(4)
    v_mfma_f32_16x16x32_bf16 v[48:51], v[40:43], v[24:27], v[48:51]
    v_mfma_f32_16x16x32_bf16 v[52:55], v[4:7], v[24:27], v[52:55]
    v_alignbit_b32 v4, v44, v44, 16
    v_alignbit_b32 v5, v45, v45, 16
    v_alignbit_b32 v6, v46, v46, 16
    v_alignbit_b32 v7, v47, v47, 16
    v_xor_b32 v4, 0x8000, v4
    v_xor_b32 v5, 0x8000, v5
    v_xor_b32 v6, 0x8000, v6
    v_xor_b32 v7, 0x8000, v7
    s_waitcnt lgkmcnt(0)
    v_mfma_f32_16x16x32_bf16 v[48:51], v[44:47], v[28:31], v[48:51]
    v_mfma_f32_16x16x32_bf16 v[52:55], v[4:7], v[28:31], v[52:55]
    s_lshl_b32 s3, s73, 1
    v_lshrrev_b32 v11, 1, v13
    v_add_u32 v11, s3, v11
    v_and_b32 v14, 7, v12
    v_xor_b32 v11, v11, v14
    v_lshlrev_b32 v11, 4, v11
    v_and_b32 v14, 1, v13
    v_lshl_add_u32 v11, v14, 3, v11
    v_lshl_add_u32 v11, v12, 7, v11
    s_lshl_b32 s3, s74, 11
    s_add_u32 s3, s3, 98304
    v_add_u32 v11, s3, v11
    v_xor_b32 v14, 64, v11
    v_mul_f32 v16, v48, v56
    v_mul_f32 v17, v48, v60
    v_fma_f32 v16, -v52, v60, v16
    v_fma_f32 v17, v52, v56, v17
    v_cvt_pk_bf16_f32 v20, v16, v17
    v_mul_f32 v16, v49, v57
    v_mul_f32 v17, v49, v61
    v_fma_f32 v16, -v53, v61, v16
    v_fma_f32 v17, v53, v57, v17
    v_cvt_pk_bf16_f32 v21, v16, v17
    v_mul_f32 v16, v50, v58
    v_mul_f32 v17, v50, v62
    v_fma_f32 v16, -v54, v62, v16
    v_fma_f32 v17, v54, v58, v17
    v_cvt_pk_bf16_f32 v22, v16, v17
    v_mul_f32 v16, v51, v59
    v_mul_f32 v17, v51, v63
    v_fma_f32 v16, -v55, v63, v16
    v_fma_f32 v17, v55, v59, v17
    v_cvt_pk_bf16_f32 v23, v16, v17
    ds_write_b128 v9, v[20:23]
    v_lshrrev_b32 v3, 3, v1
    v_xor_b32 v2, v3, v1
    v_and_b32 v2, 7, v2
    v_lshlrev_b32 v2, 4, v2
    v_lshl_add_u32 v2, v3, 7, v2
    s_lshl_b32 s3, s44, 10
    s_add_u32 s3, s3, 98304
    v_add_u32 v2, s3, v2
    v_and_b32 v9, 7, v1
    v_lshlrev_b32 v9, 4, v9
    v_lshl_add_u32 v3, v3, 15, v9
    s_waitcnt lgkmcnt(0)
    s_barrier
    ds_read_b128 v[16:19], v8 offset:0
    ds_read_b128 v[20:23], v8 offset:1024
    ds_read_b128 v[24:27], v8 offset:2048
    ds_read_b128 v[28:31], v8 offset:3072
    v_alignbit_b32 v4, v32, v32, 16
    buffer_load_dwordx4 v[96:99], v10, s[16:19], s81 offen offset:0
    v_alignbit_b32 v5, v33, v33, 16
    v_alignbit_b32 v6, v34, v34, 16
    v_alignbit_b32 v7, v35, v35, 16
    v_xor_b32 v32, 0x80000000, v32
    v_xor_b32 v33, 0x80000000, v33
    v_xor_b32 v34, 0x80000000, v34
    v_xor_b32 v35, 0x80000000, v35
    s_waitcnt lgkmcnt(3)
    buffer_load_dwordx4 v[100:103], v10, s[16:19], s81 offen offset:1024
    v_mfma_f32_16x16x32_bf16 v[52:55], v[16:19], v[4:7], 0
    v_mfma_f32_16x16x32_bf16 v[48:51], v[16:19], v[32:35], 0
    v_alignbit_b32 v4, v36, v36, 16
    v_alignbit_b32 v5, v37, v37, 16
    v_alignbit_b32 v6, v38, v38, 16
    v_alignbit_b32 v7, v39, v39, 16
    v_xor_b32 v36, 0x80000000, v36
    v_xor_b32 v37, 0x80000000, v37
    buffer_load_dwordx4 v[104:107], v10, s[16:19], s81 offen offset:2048
    v_xor_b32 v38, 0x80000000, v38
    v_xor_b32 v39, 0x80000000, v39
    s_waitcnt lgkmcnt(2)
    v_mfma_f32_16x16x32_bf16 v[52:55], v[20:23], v[4:7], v[52:55]
    v_mfma_f32_16x16x32_bf16 v[48:51], v[20:23], v[36:39], v[48:51]
    v_alignbit_b32 v4, v40, v40, 16
    v_alignbit_b32 v5, v41, v41, 16
    v_alignbit_b32 v6, v42, v42, 16
    buffer_load_dwordx4 v[108:111], v10, s[16:19], s81 offen offset:3072
    v_alignbit_b32 v7, v43, v43, 16
    v_xor_b32 v40, 0x80000000, v40
    v_xor_b32 v41, 0x80000000, v41
    v_xor_b32 v42, 0x80000000, v42
    v_xor_b32 v43, 0x80000000, v43
    s_waitcnt lgkmcnt(1)
    v_mfma_f32_16x16x32_bf16 v[52:55], v[24:27], v[4:7], v[52:55]
    v_mfma_f32_16x16x32_bf16 v[48:51], v[24:27], v[40:43], v[48:51]
    buffer_load_dwordx4 v[112:115], v10, s[16:19], s82 offen offset:0
    v_alignbit_b32 v4, v44, v44, 16
    v_alignbit_b32 v5, v45, v45, 16
    v_alignbit_b32 v6, v46, v46, 16
    v_alignbit_b32 v7, v47, v47, 16
    v_xor_b32 v44, 0x80000000, v44
    v_xor_b32 v45, 0x80000000, v45
    v_xor_b32 v46, 0x80000000, v46
    v_xor_b32 v47, 0x80000000, v47
    buffer_load_dwordx4 v[116:119], v10, s[16:19], s82 offen offset:1024
    s_waitcnt lgkmcnt(0)
    v_mfma_f32_16x16x32_bf16 v[52:55], v[28:31], v[4:7], v[52:55]
    v_mfma_f32_16x16x32_bf16 v[48:51], v[28:31], v[44:47], v[48:51]
    s_lshl_b32 s3, s44, 18
    s_lshl_b32 s4, s67, 10
    s_add_u32 s3, s3, s4
    s_lshl_b32 s4, s68, 7
    s_add_u32 s3, s3, s4
    buffer_load_dwordx4 v[120:123], v10, s[16:19], s82 offen offset:2048
    s_add_u32 s83, s3, 8388608
    v_cvt_pk_bf16_f32 v18, v52, v53
    v_cvt_pk_bf16_f32 v19, v54, v55
    v_cvt_pk_bf16_f32 v16, v48, v49
    v_cvt_pk_bf16_f32 v17, v50, v51
    ds_write_b64 v11, v[16:17]
    ds_write_b64 v14, v[18:19]
    v_lshrrev_b32 v16, 5, v1
    buffer_load_dwordx4 v[124:127], v10, s[16:19], s82 offen offset:3072
    v_and_b32 v17, 1, v13
    v_and_b32 v7, 31, v1
    s_lshl_b32 s3, s77, 5
    v_add_u32 v7, s3, v7
    v_lshlrev_b32 v7, 4, v7
    v_lshl_add_u32 v7, v16, 14, v7
    s_xor_b32 s3, s76, s72
    s_lshl_b32 s3, s3, 10
    v_add_u32 v8, s3, v7
    s_lshl_b32 s3, s44, 12
    v_add_u32 v9, s3, v10
    v_xor_b32 v11, s77, v12
    v_lshlrev_b32 v11, 4, v11
    v_lshl_add_u32 v11, v12, 8, v11
    v_lshl_add_u32 v11, v17, 3, v11
    v_lshl_add_u32 v11, v16, 2, v11
    s_lshl_b32 s3, s76, 12
    s_add_u32 s3, s3, 65536
    v_add_u32 v11, s3, v11
    s_lshl_b32 s3, s77, 1
    v_add_u32 v17, s3, v17
    v_lshlrev_b32 v17, 8, v17
    v_lshl_add_u32 v13, v12, 3, v17
    v_lshlrev_b32 v15, 16, v15
    s_mov_b32 s84, 0
    s_mov_b32 s85, -1
    s_waitcnt lgkmcnt(0)
    s_barrier
    ds_read_b128 v[20:23], v2
    s_waitcnt lgkmcnt(0)
    buffer_store_dwordx4 v[20:23], v3, s[16:19], s83 offen sc1
    s_branch L_soft_p2_t0
L_soft_p2_six:
    s_lshl_b32 s81, s54, 16
    s_add_u32 s81, s81, s71
    s_add_u32 s82, s81, 4096
    s_add_u32 m0, s52, 98304
    s_nop 0
    buffer_load_dwordx4 v10, s[16:19], s60 offen lds
    s_lshl_b32 s3, s73, 6
    s_add_u32 s3, s3, 98304
    buffer_load_dwordx4 v[96:99], v10, s[16:19], s81 offen offset:0
    v_lshlrev_b32 v8, 9, v13
    v_lshl_add_u32 v8, v12, 2, v8
    v_add_u32 v8, s3, v8
    buffer_load_dwordx4 v[100:103], v10, s[16:19], s81 offen offset:1024
    v_add_u32 v9, s75, v12
    v_cmp_eq_u32 vcc, 0x100, v9
    v_mov_b32 v14, 0x36000000
    buffer_load_dwordx4 v[104:107], v10, s[16:19], s81 offen offset:2048
    v_mov_b32 v9, 0x35800000
    v_cndmask_b32 v14, v14, v9, vcc
    v_lshlrev_b32 v56, 16, v56
    buffer_load_dwordx4 v[108:111], v10, s[16:19], s81 offen offset:3072
    v_mul_f32 v56, v14, v56
    v_lshlrev_b32 v57, 16, v57
    v_mul_f32 v57, v14, v57
    buffer_load_dwordx4 v[112:115], v10, s[16:19], s82 offen offset:0
    v_lshlrev_b32 v58, 16, v58
    v_mul_f32 v58, v14, v58
    v_lshlrev_b32 v59, 16, v59
    buffer_load_dwordx4 v[116:119], v10, s[16:19], s82 offen offset:1024
    v_mul_f32 v59, v14, v59
    v_lshlrev_b32 v60, 16, v60
    v_mul_f32 v60, v14, v60
    buffer_load_dwordx4 v[120:123], v10, s[16:19], s82 offen offset:2048
    v_lshlrev_b32 v61, 16, v61
    v_mul_f32 v61, v14, v61
    v_lshlrev_b32 v62, 16, v62
    buffer_load_dwordx4 v[124:127], v10, s[16:19], s82 offen offset:3072
    v_mul_f32 v62, v14, v62
    v_lshlrev_b32 v63, 16, v63
    v_mul_f32 v63, v14, v63
    s_waitcnt vmcnt(8)
    s_barrier
    s_add_u32 m0, s52, 65536
    s_add_u32 s7, s53, 0
    buffer_load_dwordx4 v4, s[16:19], s7 offen lds
    s_add_u32 m0, s52, 73728
    s_add_u32 s7, s53, 1408
    buffer_load_dwordx4 v4, s[16:19], s7 offen lds
    ds_read_b32 v16, v8 offset:0
    ds_read_b32 v17, v8 offset:128
    ds_read_b32 v18, v8 offset:256
    ds_read_b32 v19, v8 offset:384
    ds_read_b32 v20, v8 offset:2048
    ds_read_b32 v21, v8 offset:2176
    ds_read_b32 v22, v8 offset:2304
    ds_read_b32 v23, v8 offset:2432
    ds_read_b32 v24, v8 offset:4096
    ds_read_b32 v25, v8 offset:4224
    ds_read_b32 v26, v8 offset:4352
    ds_read_b32 v27, v8 offset:4480
    ds_read_b32 v28, v8 offset:6144
    ds_read_b32 v29, v8 offset:6272
    ds_read_b32 v30, v8 offset:6400
    ds_read_b32 v31, v8 offset:6528
    s_lshl_b32 s3, s73, 12
    s_add_u32 s3, s3, 106496
    v_add_u32 v8, s3, v10
    s_lshl_b32 s3, s74, 10
    v_add_u32 v9, s3, v8
    v_alignbit_b32 v4, v32, v32, 16
    v_alignbit_b32 v5, v33, v33, 16
    v_alignbit_b32 v6, v34, v34, 16
    v_alignbit_b32 v7, v35, v35, 16
    v_xor_b32 v4, 0x8000, v4
    v_xor_b32 v5, 0x8000, v5
    v_xor_b32 v6, 0x8000, v6
    v_xor_b32 v7, 0x8000, v7
    s_waitcnt lgkmcnt(12)
    v_mfma_f32_16x16x32_bf16 v[48:51], v[32:35], v[16:19], 0
    v_mfma_f32_16x16x32_bf16 v[52:55], v[4:7], v[16:19], 0
    v_alignbit_b32 v4, v36, v36, 16
    v_alignbit_b32 v5, v37, v37, 16
    v_alignbit_b32 v6, v38, v38, 16
    v_alignbit_b32 v7, v39, v39, 16
    v_xor_b32 v4, 0x8000, v4
    v_xor_b32 v5, 0x8000, v5
    v_xor_b32 v6, 0x8000, v6
    v_xor_b32 v7, 0x8000, v7
    s_waitcnt lgkmcnt(8)
    v_mfma_f32_16x16x32_bf16 v[48:51], v[36:39], v[20:23], v[48:51]
    v_mfma_f32_16x16x32_bf16 v[52:55], v[4:7], v[20:23], v[52:55]
    v_alignbit_b32 v4, v40, v40, 16
    v_alignbit_b32 v5, v41, v41, 16
    v_alignbit_b32 v6, v42, v42, 16
    v_alignbit_b32 v7, v43, v43, 16
    v_xor_b32 v4, 0x8000, v4
    v_xor_b32 v5, 0x8000, v5
    v_xor_b32 v6, 0x8000, v6
    v_xor_b32 v7, 0x8000, v7
    s_waitcnt lgkmcnt(4)
    v_mfma_f32_16x16x32_bf16 v[48:51], v[40:43], v[24:27], v[48:51]
    v_mfma_f32_16x16x32_bf16 v[52:55], v[4:7], v[24:27], v[52:55]
    v_alignbit_b32 v4, v44, v44, 16
    v_alignbit_b32 v5, v45, v45, 16
    v_alignbit_b32 v6, v46, v46, 16
    v_alignbit_b32 v7, v47, v47, 16
    v_xor_b32 v4, 0x8000, v4
    v_xor_b32 v5, 0x8000, v5
    v_xor_b32 v6, 0x8000, v6
    v_xor_b32 v7, 0x8000, v7
    s_waitcnt lgkmcnt(0)
    v_mfma_f32_16x16x32_bf16 v[48:51], v[44:47], v[28:31], v[48:51]
    v_mfma_f32_16x16x32_bf16 v[52:55], v[4:7], v[28:31], v[52:55]
    s_lshl_b32 s3, s73, 1
    v_lshrrev_b32 v11, 1, v13
    v_add_u32 v11, s3, v11
    v_and_b32 v14, 7, v12
    v_xor_b32 v11, v11, v14
    v_lshlrev_b32 v11, 4, v11
    v_and_b32 v14, 1, v13
    v_lshl_add_u32 v11, v14, 3, v11
    v_lshl_add_u32 v11, v12, 7, v11
    s_lshl_b32 s3, s74, 11
    s_add_u32 s3, s3, 98304
    v_add_u32 v11, s3, v11
    v_xor_b32 v14, 64, v11
    v_mul_f32 v16, v48, v56
    v_mul_f32 v17, v48, v60
    v_fma_f32 v16, -v52, v60, v16
    v_fma_f32 v17, v52, v56, v17
    v_cvt_pk_bf16_f32 v20, v16, v17
    v_mul_f32 v16, v49, v57
    v_mul_f32 v17, v49, v61
    v_fma_f32 v16, -v53, v61, v16
    v_fma_f32 v17, v53, v57, v17
    v_cvt_pk_bf16_f32 v21, v16, v17
    v_mul_f32 v16, v50, v58
    v_mul_f32 v17, v50, v62
    v_fma_f32 v16, -v54, v62, v16
    v_fma_f32 v17, v54, v58, v17
    v_cvt_pk_bf16_f32 v22, v16, v17
    v_mul_f32 v16, v51, v59
    v_mul_f32 v17, v51, v63
    v_fma_f32 v16, -v55, v63, v16
    v_fma_f32 v17, v55, v59, v17
    v_cvt_pk_bf16_f32 v23, v16, v17
    ds_write_b128 v9, v[20:23]
    v_lshrrev_b32 v3, 3, v1
    v_xor_b32 v2, v3, v1
    v_and_b32 v2, 7, v2
    v_lshlrev_b32 v2, 4, v2
    v_lshl_add_u32 v2, v3, 7, v2
    s_lshl_b32 s3, s44, 10
    s_add_u32 s3, s3, 98304
    v_add_u32 v2, s3, v2
    v_and_b32 v9, 7, v1
    v_lshlrev_b32 v9, 4, v9
    v_lshl_add_u32 v3, v3, 15, v9
    s_waitcnt lgkmcnt(0)
    s_barrier
    ds_read_b128 v[16:19], v8 offset:0
    ds_read_b128 v[20:23], v8 offset:1024
    ds_read_b128 v[24:27], v8 offset:2048
    ds_read_b128 v[28:31], v8 offset:3072
    v_alignbit_b32 v4, v32, v32, 16
    buffer_load_dwordx4 v[64:67], v10, s[16:19], s79 offen offset:0
    v_alignbit_b32 v5, v33, v33, 16
    v_alignbit_b32 v6, v34, v34, 16
    v_alignbit_b32 v7, v35, v35, 16
    v_xor_b32 v32, 0x80000000, v32
    v_xor_b32 v33, 0x80000000, v33
    v_xor_b32 v34, 0x80000000, v34
    v_xor_b32 v35, 0x80000000, v35
    s_waitcnt lgkmcnt(3)
    buffer_load_dwordx4 v[68:71], v10, s[16:19], s79 offen offset:1024
    v_mfma_f32_16x16x32_bf16 v[52:55], v[16:19], v[4:7], 0
    v_mfma_f32_16x16x32_bf16 v[48:51], v[16:19], v[32:35], 0
    v_alignbit_b32 v4, v36, v36, 16
    v_alignbit_b32 v5, v37, v37, 16
    v_alignbit_b32 v6, v38, v38, 16
    v_alignbit_b32 v7, v39, v39, 16
    v_xor_b32 v36, 0x80000000, v36
    v_xor_b32 v37, 0x80000000, v37
    buffer_load_dwordx4 v[72:75], v10, s[16:19], s79 offen offset:2048
    v_xor_b32 v38, 0x80000000, v38
    v_xor_b32 v39, 0x80000000, v39
    s_waitcnt lgkmcnt(2)
    v_mfma_f32_16x16x32_bf16 v[52:55], v[20:23], v[4:7], v[52:55]
    v_mfma_f32_16x16x32_bf16 v[48:51], v[20:23], v[36:39], v[48:51]
    v_alignbit_b32 v4, v40, v40, 16
    v_alignbit_b32 v5, v41, v41, 16
    v_alignbit_b32 v6, v42, v42, 16
    buffer_load_dwordx4 v[76:79], v10, s[16:19], s79 offen offset:3072
    v_alignbit_b32 v7, v43, v43, 16
    v_xor_b32 v40, 0x80000000, v40
    v_xor_b32 v41, 0x80000000, v41
    v_xor_b32 v42, 0x80000000, v42
    v_xor_b32 v43, 0x80000000, v43
    s_waitcnt lgkmcnt(1)
    v_mfma_f32_16x16x32_bf16 v[52:55], v[24:27], v[4:7], v[52:55]
    v_mfma_f32_16x16x32_bf16 v[48:51], v[24:27], v[40:43], v[48:51]
    buffer_load_dwordx4 v[80:83], v10, s[16:19], s80 offen offset:0
    v_alignbit_b32 v4, v44, v44, 16
    v_alignbit_b32 v5, v45, v45, 16
    v_alignbit_b32 v6, v46, v46, 16
    v_alignbit_b32 v7, v47, v47, 16
    v_xor_b32 v44, 0x80000000, v44
    v_xor_b32 v45, 0x80000000, v45
    v_xor_b32 v46, 0x80000000, v46
    v_xor_b32 v47, 0x80000000, v47
    buffer_load_dwordx4 v[84:87], v10, s[16:19], s80 offen offset:1024
    s_waitcnt lgkmcnt(0)
    v_mfma_f32_16x16x32_bf16 v[52:55], v[28:31], v[4:7], v[52:55]
    v_mfma_f32_16x16x32_bf16 v[48:51], v[28:31], v[44:47], v[48:51]
    s_lshl_b32 s3, s44, 18
    s_lshl_b32 s4, s67, 10
    s_add_u32 s3, s3, s4
    s_lshl_b32 s4, s68, 7
    s_add_u32 s3, s3, s4
    buffer_load_dwordx4 v[88:91], v10, s[16:19], s80 offen offset:2048
    s_add_u32 s83, s3, 8388608
    v_cvt_pk_bf16_f32 v18, v52, v53
    v_cvt_pk_bf16_f32 v19, v54, v55
    v_cvt_pk_bf16_f32 v16, v48, v49
    v_cvt_pk_bf16_f32 v17, v50, v51
    ds_write_b64 v11, v[16:17]
    ds_write_b64 v14, v[18:19]
    v_lshrrev_b32 v16, 5, v1
    buffer_load_dwordx4 v[92:95], v10, s[16:19], s80 offen offset:3072
    v_and_b32 v17, 1, v13
    v_and_b32 v7, 31, v1
    s_lshl_b32 s3, s77, 5
    v_add_u32 v7, s3, v7
    v_lshlrev_b32 v7, 4, v7
    v_lshl_add_u32 v7, v16, 14, v7
    s_xor_b32 s3, s76, s72
    s_lshl_b32 s3, s3, 10
    v_add_u32 v8, s3, v7
    s_lshl_b32 s3, s44, 12
    v_add_u32 v9, s3, v10
    v_xor_b32 v11, s77, v12
    v_lshlrev_b32 v11, 4, v11
    v_lshl_add_u32 v11, v12, 8, v11
    v_lshl_add_u32 v11, v17, 3, v11
    v_lshl_add_u32 v11, v16, 2, v11
    s_lshl_b32 s3, s76, 12
    s_add_u32 s3, s3, 65536
    v_add_u32 v11, s3, v11
    s_lshl_b32 s3, s77, 1
    v_add_u32 v17, s3, v17
    v_lshlrev_b32 v17, 8, v17
    v_lshl_add_u32 v13, v12, 3, v17
    v_lshlrev_b32 v15, 16, v15
    s_mov_b32 s84, 0
    s_mov_b32 s85, -1
    s_waitcnt lgkmcnt(0)
    s_barrier
    ds_read_b128 v[20:23], v2
    s_waitcnt lgkmcnt(0)
    buffer_store_dwordx4 v[20:23], v3, s[16:19], s83 offen sc1
    s_lshl_b32 s81, s56, 16
    s_add_u32 s81, s81, s71
    s_add_u32 s82, s81, 4096
    s_waitcnt vmcnt(17)
    v_mfma_f32_16x16x32_bf16 v[48:51], v[96:99], v[128:131], 0
    v_mfma_f32_16x16x32_bf16 v[52:55], v[96:99], v[160:163], 0
    v_mfma_f32_16x16x32_bf16 v[56:59], v[96:99], v[192:195], 0
    v_mfma_f32_16x16x32_bf16 v[60:63], v[96:99], v[224:227], 0
    v_mfma_f32_16x16x32_bf16 v[48:51], v[100:103], v[132:135], v[48:51]
    buffer_load_dwordx4 v[96:99], v10, s[16:19], s81 offen offset:0
    v_mfma_f32_16x16x32_bf16 v[52:55], v[100:103], v[164:167], v[52:55]
    v_mfma_f32_16x16x32_bf16 v[56:59], v[100:103], v[196:199], v[56:59]
    v_mfma_f32_16x16x32_bf16 v[60:63], v[100:103], v[228:231], v[60:63]
    s_waitcnt vmcnt(16)
    v_mfma_f32_16x16x32_bf16 v[48:51], v[104:107], v[136:139], v[48:51]
    buffer_load_dwordx4 v[100:103], v10, s[16:19], s81 offen offset:1024
    v_mfma_f32_16x16x32_bf16 v[52:55], v[104:107], v[168:171], v[52:55]
    v_mfma_f32_16x16x32_bf16 v[56:59], v[104:107], v[200:203], v[56:59]
    v_mfma_f32_16x16x32_bf16 v[60:63], v[104:107], v[232:235], v[60:63]
    v_mfma_f32_16x16x32_bf16 v[48:51], v[108:111], v[140:143], v[48:51]
    buffer_load_dwordx4 v[104:107], v10, s[16:19], s81 offen offset:2048
    v_mfma_f32_16x16x32_bf16 v[52:55], v[108:111], v[172:175], v[52:55]
    v_mfma_f32_16x16x32_bf16 v[56:59], v[108:111], v[204:207], v[56:59]
    v_mfma_f32_16x16x32_bf16 v[60:63], v[108:111], v[236:239], v[60:63]
    s_waitcnt vmcnt(16)
    v_mfma_f32_16x16x32_bf16 v[48:51], v[112:115], v[144:147], v[48:51]
    buffer_load_dwordx4 v[108:111], v10, s[16:19], s81 offen offset:3072
    v_mfma_f32_16x16x32_bf16 v[52:55], v[112:115], v[176:179], v[52:55]
    v_mfma_f32_16x16x32_bf16 v[56:59], v[112:115], v[208:211], v[56:59]
    v_mfma_f32_16x16x32_bf16 v[60:63], v[112:115], v[240:243], v[60:63]
    v_mfma_f32_16x16x32_bf16 v[48:51], v[116:119], v[148:151], v[48:51]
    buffer_load_dwordx4 v[112:115], v10, s[16:19], s82 offen offset:0
    v_mfma_f32_16x16x32_bf16 v[52:55], v[116:119], v[180:183], v[52:55]
    v_mfma_f32_16x16x32_bf16 v[56:59], v[116:119], v[212:215], v[56:59]
    v_mfma_f32_16x16x32_bf16 v[60:63], v[116:119], v[244:247], v[60:63]
    s_waitcnt vmcnt(16)
    v_mfma_f32_16x16x32_bf16 v[48:51], v[120:123], v[152:155], v[48:51]
    buffer_load_dwordx4 v[116:119], v10, s[16:19], s82 offen offset:1024
    v_mfma_f32_16x16x32_bf16 v[52:55], v[120:123], v[184:187], v[52:55]
    v_mfma_f32_16x16x32_bf16 v[56:59], v[120:123], v[216:219], v[56:59]
    v_mfma_f32_16x16x32_bf16 v[60:63], v[120:123], v[248:251], v[60:63]
    v_mfma_f32_16x16x32_bf16 v[48:51], v[124:127], v[156:159], v[48:51]
    buffer_load_dwordx4 v[120:123], v10, s[16:19], s82 offen offset:2048
    v_mfma_f32_16x16x32_bf16 v[52:55], v[124:127], v[188:191], v[52:55]
    v_mfma_f32_16x16x32_bf16 v[56:59], v[124:127], v[220:223], v[56:59]
    v_mfma_f32_16x16x32_bf16 v[60:63], v[124:127], v[252:255], v[60:63]
    buffer_load_dwordx4 v[124:127], v10, s[16:19], s82 offen offset:3072
L_soft_p2_t0:
    s_lshl_b32 s79, s57, 16
    s_add_u32 s79, s79, s71
    s_add_u32 s80, s79, 4096
    s_waitcnt vmcnt(15)
    v_mfma_f32_16x16x32_bf16 v[32:35], v[64:67], v[128:131], 0
    v_mfma_f32_16x16x32_bf16 v[36:39], v[64:67], v[160:163], 0
    v_mfma_f32_16x16x32_bf16 v[40:43], v[64:67], v[192:195], 0
    ds_write_b128 v9, v[48:51] offset:32768
    v_mfma_f32_16x16x32_bf16 v[44:47], v[64:67], v[224:227], 0
    v_mfma_f32_16x16x32_bf16 v[32:35], v[68:71], v[132:135], v[32:35]
    buffer_load_dwordx4 v[64:67], v10, s[16:19], s79 offen offset:0
    v_mfma_f32_16x16x32_bf16 v[36:39], v[68:71], v[164:167], v[36:39]
    ds_write_b128 v9, v[52:55] offset:33792
    v_mfma_f32_16x16x32_bf16 v[40:43], v[68:71], v[196:199], v[40:43]
    v_mfma_f32_16x16x32_bf16 v[44:47], v[68:71], v[228:231], v[44:47]
    ds_write_b128 v9, v[56:59] offset:34816
    s_waitcnt vmcnt(14)
    v_mfma_f32_16x16x32_bf16 v[32:35], v[72:75], v[136:139], v[32:35]
    buffer_load_dwordx4 v[68:71], v10, s[16:19], s79 offen offset:1024
    v_mfma_f32_16x16x32_bf16 v[36:39], v[72:75], v[168:171], v[36:39]
    v_mfma_f32_16x16x32_bf16 v[40:43], v[72:75], v[200:203], v[40:43]
    ds_write_b128 v9, v[60:63] offset:35840
    v_mfma_f32_16x16x32_bf16 v[44:47], v[72:75], v[232:235], v[44:47]
    v_mfma_f32_16x16x32_bf16 v[32:35], v[76:79], v[140:143], v[32:35]
    buffer_load_dwordx4 v[72:75], v10, s[16:19], s79 offen offset:2048
    v_mfma_f32_16x16x32_bf16 v[36:39], v[76:79], v[172:175], v[36:39]
    v_mfma_f32_16x16x32_bf16 v[40:43], v[76:79], v[204:207], v[40:43]
    v_mfma_f32_16x16x32_bf16 v[44:47], v[76:79], v[236:239], v[44:47]
    s_lshl_b32 s4, s54, 5
    s_and_b32 s4, s4, 0xff
    s_waitcnt vmcnt(14)
    v_mfma_f32_16x16x32_bf16 v[32:35], v[80:83], v[144:147], v[32:35]
    buffer_load_dwordx4 v[76:79], v10, s[16:19], s79 offen offset:3072
    s_waitcnt lgkmcnt(0)
    s_waitcnt vmcnt(4)
    s_barrier
    s_cmp_lg_u32 s44, 0
    s_nop 1
    s_cbranch_scc1 L_soft_p2_c
    s_lshr_b32 s3, s2, 5
    s_lshl_b32 s3, s3, 8
    s_and_b32 s5, s2, 31
    s_lshl_b32 s5, s5, 2
    s_add_u32 s3, s3, s5
    s_add_u32 s3, s3, 14712832
    v_mul_u32_u24 v2, 2048, v1
    v_cmp_gt_u32 vcc, 8, v1
    v_mov_b32 v3, 0x40000000
    s_nop 0
    v_cndmask_b32 v2, v3, v2, vcc
    v_mov_b32 v3, s45
    buffer_store_dword v3, v2, s[16:19], s3 offen sc1
L_soft_p2_c:
    v_xor_b32 v14, s4, v11
    ds_read_b128 v[16:19], v8 offset:32768
    v_mfma_f32_16x16x32_bf16 v[36:39], v[80:83], v[176:179], v[36:39]
    ds_read_b128 v[20:23], v8 offset:36864
    ds_read_b128 v[24:27], v8 offset:40960
    v_mfma_f32_16x16x32_bf16 v[40:43], v[80:83], v[208:211], v[40:43]
    ds_read_b128 v[28:31], v8 offset:45056
    ds_read_b32 v14, v14
    v_mfma_f32_16x16x32_bf16 v[44:47], v[80:83], v[240:243], v[44:47]
    v_mfma_f32_16x16x32_bf16 v[32:35], v[84:87], v[148:151], v[32:35]
    buffer_load_dwordx4 v[80:83], v10, s[16:19], s80 offen offset:0
    v_mfma_f32_16x16x32_bf16 v[36:39], v[84:87], v[180:183], v[36:39]
    v_mfma_f32_16x16x32_bf16 v[40:43], v[84:87], v[212:215], v[40:43]
    v_mfma_f32_16x16x32_bf16 v[44:47], v[84:87], v[244:247], v[44:47]
    s_waitcnt lgkmcnt(0)
    s_waitcnt vmcnt(14)
    v_mfma_f32_16x16x32_bf16 v[32:35], v[88:91], v[152:155], v[32:35]
    buffer_load_dwordx4 v[84:87], v10, s[16:19], s80 offen offset:1024
    v_add_f32 v16, v16, v20
    v_mfma_f32_16x16x32_bf16 v[36:39], v[88:91], v[184:187], v[36:39]
    v_add_f32 v24, v24, v28
    v_add_f32 v17, v17, v21
    v_mfma_f32_16x16x32_bf16 v[40:43], v[88:91], v[216:219], v[40:43]
    v_add_f32 v25, v25, v29
    v_mfma_f32_16x16x32_bf16 v[44:47], v[88:91], v[248:251], v[44:47]
    v_add_f32 v18, v18, v22
    v_add_f32 v26, v26, v30
    v_mfma_f32_16x16x32_bf16 v[32:35], v[92:95], v[156:159], v[32:35]
    buffer_load_dwordx4 v[88:91], v10, s[16:19], s80 offen offset:2048
    v_add_f32 v19, v19, v23
    v_mfma_f32_16x16x32_bf16 v[36:39], v[92:95], v[188:191], v[36:39]
    v_add_f32 v27, v27, v31
    v_add_f32 v16, v16, v24
    v_mfma_f32_16x16x32_bf16 v[40:43], v[92:95], v[220:223], v[40:43]
    v_add_f32 v17, v17, v25
    v_mfma_f32_16x16x32_bf16 v[44:47], v[92:95], v[252:255], v[44:47]
    buffer_load_dwordx4 v[92:95], v10, s[16:19], s80 offen offset:3072
    v_add_f32 v18, v18, v26
    v_add_f32 v19, v19, v27
    s_lshl_b32 s81, s58, 16
    s_add_u32 s81, s81, s71
    s_add_u32 s82, s81, 4096
    s_waitcnt vmcnt(14)
    v_mfma_f32_16x16x32_bf16 v[48:51], v[96:99], v[128:131], 0
    v_lshlrev_b32 v20, 16, v14
    v_mfma_f32_16x16x32_bf16 v[52:55], v[96:99], v[160:163], 0
    v_mfma_f32_16x16x32_bf16 v[56:59], v[96:99], v[192:195], 0
    v_and_b32 v21, 0xffff0000, v14
    ds_write_b128 v9, v[32:35] offset:0
    v_mfma_f32_16x16x32_bf16 v[60:63], v[96:99], v[224:227], 0
    v_permlane32_swap_b32 v16, v18
    v_mfma_f32_16x16x32_bf16 v[48:51], v[100:103], v[132:135], v[48:51]
    buffer_load_dwordx4 v[96:99], v10, s[16:19], s81 offen offset:0
    v_mfma_f32_16x16x32_bf16 v[52:55], v[100:103], v[164:167], v[52:55]
    v_permlane32_swap_b32 v17, v19
    ds_write_b128 v9, v[36:39] offset:1024
    v_mfma_f32_16x16x32_bf16 v[56:59], v[100:103], v[196:199], v[56:59]
    v_add_f32 v16, v16, v18
    v_mfma_f32_16x16x32_bf16 v[60:63], v[100:103], v[228:231], v[60:63]
    ds_write_b128 v9, v[40:43] offset:2048
    s_waitcnt vmcnt(13)
    v_mfma_f32_16x16x32_bf16 v[48:51], v[104:107], v[136:139], v[48:51]
    buffer_load_dwordx4 v[100:103], v10, s[16:19], s81 offen offset:1024
    v_add_f32 v17, v17, v19
    v_mfma_f32_16x16x32_bf16 v[52:55], v[104:107], v[168:171], v[52:55]
    v_add_f32 v16, v16, v15
    v_mfma_f32_16x16x32_bf16 v[56:59], v[104:107], v[200:203], v[56:59]
    v_add_f32 v17, v17, v15
    ds_write_b128 v9, v[44:47] offset:3072
    v_mfma_f32_16x16x32_bf16 v[60:63], v[104:107], v[232:235], v[60:63]
    v_mul_f32 v16, v16, v20
    v_mfma_f32_16x16x32_bf16 v[48:51], v[108:111], v[140:143], v[48:51]
    buffer_load_dwordx4 v[104:107], v10, s[16:19], s81 offen offset:2048
    v_mfma_f32_16x16x32_bf16 v[52:55], v[108:111], v[172:175], v[52:55]
    v_mul_f32 v17, v17, v21
    v_mfma_f32_16x16x32_bf16 v[56:59], v[108:111], v[204:207], v[56:59]
    v_cvt_pk_bf16_f32 v6, v16, v17
    v_mfma_f32_16x16x32_bf16 v[60:63], v[108:111], v[236:239], v[60:63]
    s_lshl_b32 s4, s55, 5
    s_and_b32 s4, s4, 0xff
    s_waitcnt vmcnt(13)
    v_mfma_f32_16x16x32_bf16 v[48:51], v[112:115], v[144:147], v[48:51]
    buffer_load_dwordx4 v[108:111], v10, s[16:19], s81 offen offset:3072
    s_waitcnt lgkmcnt(0)
    s_barrier
    v_xor_b32 v14, s4, v11
    ds_read_b128 v[16:19], v8 offset:0
    v_mfma_f32_16x16x32_bf16 v[52:55], v[112:115], v[176:179], v[52:55]
    ds_read_b128 v[20:23], v8 offset:4096
    ds_read_b128 v[24:27], v8 offset:8192
    v_mfma_f32_16x16x32_bf16 v[56:59], v[112:115], v[208:211], v[56:59]
    ds_read_b128 v[28:31], v8 offset:12288
    ds_read_b32 v14, v14
    v_mfma_f32_16x16x32_bf16 v[60:63], v[112:115], v[240:243], v[60:63]
    v_mfma_f32_16x16x32_bf16 v[48:51], v[116:119], v[148:151], v[48:51]
    buffer_load_dwordx4 v[112:115], v10, s[16:19], s82 offen offset:0
    v_mfma_f32_16x16x32_bf16 v[52:55], v[116:119], v[180:183], v[52:55]
    v_mfma_f32_16x16x32_bf16 v[56:59], v[116:119], v[212:215], v[56:59]
    v_mfma_f32_16x16x32_bf16 v[60:63], v[116:119], v[244:247], v[60:63]
    s_waitcnt lgkmcnt(0)
    s_waitcnt vmcnt(13)
    v_mfma_f32_16x16x32_bf16 v[48:51], v[120:123], v[152:155], v[48:51]
    buffer_load_dwordx4 v[116:119], v10, s[16:19], s82 offen offset:1024
    v_add_f32 v16, v16, v20
    v_mfma_f32_16x16x32_bf16 v[52:55], v[120:123], v[184:187], v[52:55]
    v_add_f32 v24, v24, v28
    v_add_f32 v17, v17, v21
    v_mfma_f32_16x16x32_bf16 v[56:59], v[120:123], v[216:219], v[56:59]
    v_add_f32 v25, v25, v29
    v_mfma_f32_16x16x32_bf16 v[60:63], v[120:123], v[248:251], v[60:63]
    v_add_f32 v18, v18, v22
    v_add_f32 v26, v26, v30
    v_mfma_f32_16x16x32_bf16 v[48:51], v[124:127], v[156:159], v[48:51]
    buffer_load_dwordx4 v[120:123], v10, s[16:19], s82 offen offset:2048
    v_add_f32 v19, v19, v23
    v_mfma_f32_16x16x32_bf16 v[52:55], v[124:127], v[188:191], v[52:55]
    v_add_f32 v27, v27, v31
    v_add_f32 v16, v16, v24
    v_mfma_f32_16x16x32_bf16 v[56:59], v[124:127], v[220:223], v[56:59]
    v_add_f32 v17, v17, v25
    v_mfma_f32_16x16x32_bf16 v[60:63], v[124:127], v[252:255], v[60:63]
    buffer_load_dwordx4 v[124:127], v10, s[16:19], s82 offen offset:3072
    v_add_f32 v18, v18, v26
    v_add_f32 v19, v19, v27
    s_lshl_b32 s79, s59, 16
    s_add_u32 s79, s79, s71
    s_add_u32 s80, s79, 4096
    s_waitcnt vmcnt(14)
    v_mfma_f32_16x16x32_bf16 v[32:35], v[64:67], v[128:131], 0
    v_lshlrev_b32 v20, 16, v14
    v_mfma_f32_16x16x32_bf16 v[36:39], v[64:67], v[160:163], 0
    v_mfma_f32_16x16x32_bf16 v[40:43], v[64:67], v[192:195], 0
    v_and_b32 v21, 0xffff0000, v14
    v_permlane32_swap_b32 v16, v18
    ds_write_b128 v9, v[48:51] offset:32768
    v_mfma_f32_16x16x32_bf16 v[44:47], v[64:67], v[224:227], 0
    v_permlane32_swap_b32 v17, v19
    v_mfma_f32_16x16x32_bf16 v[32:35], v[68:71], v[132:135], v[32:35]
    buffer_load_dwordx4 v[64:67], v10, s[16:19], s79 offen offset:0
    v_mfma_f32_16x16x32_bf16 v[36:39], v[68:71], v[164:167], v[36:39]
    v_add_f32 v16, v16, v18
    v_add_f32 v17, v17, v19
    ds_write_b128 v9, v[52:55] offset:33792
    v_mfma_f32_16x16x32_bf16 v[40:43], v[68:71], v[196:199], v[40:43]
    v_add_f32 v16, v16, v15
    v_mfma_f32_16x16x32_bf16 v[44:47], v[68:71], v[228:231], v[44:47]
    ds_write_b128 v9, v[56:59] offset:34816
    s_waitcnt vmcnt(13)
    v_mfma_f32_16x16x32_bf16 v[32:35], v[72:75], v[136:139], v[32:35]
    buffer_load_dwordx4 v[68:71], v10, s[16:19], s79 offen offset:1024
    v_add_f32 v17, v17, v15
    v_mul_f32 v16, v16, v20
    v_mfma_f32_16x16x32_bf16 v[36:39], v[72:75], v[168:171], v[36:39]
    v_mul_f32 v17, v17, v21
    v_mfma_f32_16x16x32_bf16 v[40:43], v[72:75], v[200:203], v[40:43]
    v_cvt_pk_bf16_f32 v7, v16, v17
    v_mov_b32 v18, s54
    ds_write_b128 v9, v[60:63] offset:35840
    v_mfma_f32_16x16x32_bf16 v[44:47], v[72:75], v[232:235], v[44:47]
    v_mov_b32 v19, s55
    v_mfma_f32_16x16x32_bf16 v[32:35], v[76:79], v[140:143], v[32:35]
    buffer_load_dwordx4 v[72:75], v10, s[16:19], s79 offen offset:2048
    v_mfma_f32_16x16x32_bf16 v[36:39], v[76:79], v[172:175], v[36:39]
    v_cndmask_b32 v18, v18, v19, s[84:85]
    v_lshl_add_u32 v18, v18, 10, v13
    v_mfma_f32_16x16x32_bf16 v[40:43], v[76:79], v[204:207], v[40:43]
    v_permlane32_swap_b32 v6, v7
    buffer_store_dwordx2 v[6:7], v18, s[16:19], s78 offen sc1
    v_mfma_f32_16x16x32_bf16 v[44:47], v[76:79], v[236:239], v[44:47]
    s_lshl_b32 s4, s56, 5
    s_and_b32 s4, s4, 0xff
    s_waitcnt vmcnt(14)
    v_mfma_f32_16x16x32_bf16 v[32:35], v[80:83], v[144:147], v[32:35]
    buffer_load_dwordx4 v[76:79], v10, s[16:19], s79 offen offset:3072
    s_waitcnt lgkmcnt(0)
    s_barrier
    v_xor_b32 v14, s4, v11
    ds_read_b128 v[16:19], v8 offset:32768
    v_mfma_f32_16x16x32_bf16 v[36:39], v[80:83], v[176:179], v[36:39]
    ds_read_b128 v[20:23], v8 offset:36864
    ds_read_b128 v[24:27], v8 offset:40960
    v_mfma_f32_16x16x32_bf16 v[40:43], v[80:83], v[208:211], v[40:43]
    ds_read_b128 v[28:31], v8 offset:45056
    ds_read_b32 v14, v14
    v_mfma_f32_16x16x32_bf16 v[44:47], v[80:83], v[240:243], v[44:47]
    v_mfma_f32_16x16x32_bf16 v[32:35], v[84:87], v[148:151], v[32:35]
    buffer_load_dwordx4 v[80:83], v10, s[16:19], s80 offen offset:0
    v_mfma_f32_16x16x32_bf16 v[36:39], v[84:87], v[180:183], v[36:39]
    v_mfma_f32_16x16x32_bf16 v[40:43], v[84:87], v[212:215], v[40:43]
    v_mfma_f32_16x16x32_bf16 v[44:47], v[84:87], v[244:247], v[44:47]
    s_waitcnt lgkmcnt(0)
    s_waitcnt vmcnt(14)
    v_mfma_f32_16x16x32_bf16 v[32:35], v[88:91], v[152:155], v[32:35]
    buffer_load_dwordx4 v[84:87], v10, s[16:19], s80 offen offset:1024
    v_add_f32 v16, v16, v20
    v_mfma_f32_16x16x32_bf16 v[36:39], v[88:91], v[184:187], v[36:39]
    v_add_f32 v24, v24, v28
    v_add_f32 v17, v17, v21
    v_mfma_f32_16x16x32_bf16 v[40:43], v[88:91], v[216:219], v[40:43]
    v_add_f32 v25, v25, v29
    v_mfma_f32_16x16x32_bf16 v[44:47], v[88:91], v[248:251], v[44:47]
    v_add_f32 v18, v18, v22
    v_add_f32 v26, v26, v30
    v_mfma_f32_16x16x32_bf16 v[32:35], v[92:95], v[156:159], v[32:35]
    buffer_load_dwordx4 v[88:91], v10, s[16:19], s80 offen offset:2048
    v_add_f32 v19, v19, v23
    v_mfma_f32_16x16x32_bf16 v[36:39], v[92:95], v[188:191], v[36:39]
    v_add_f32 v27, v27, v31
    v_add_f32 v16, v16, v24
    v_mfma_f32_16x16x32_bf16 v[40:43], v[92:95], v[220:223], v[40:43]
    v_add_f32 v17, v17, v25
    v_mfma_f32_16x16x32_bf16 v[44:47], v[92:95], v[252:255], v[44:47]
    buffer_load_dwordx4 v[92:95], v10, s[16:19], s80 offen offset:3072
    v_add_f32 v18, v18, v26
    v_add_f32 v19, v19, v27
    s_and_b32 s4, s2, 7
    s_lshr_b32 s5, s2, 3
    s_lshl_b32 s46, s4, 3
    s_and_b32 s3, s5, 7
    s_add_u32 s46, s46, s3
    s_lshr_b32 s47, s5, 3
    s_and_b32 s48, s44, 1
    s_bfe_u32 s49, s44, 0x10001
    s_cmp_ge_u32 s44, 4
    s_cbranch_scc1 L_soft_p3_dft
    s_lshl_b32 s3, s47, 6
    s_lshl_b32 s4, s48, 5
    s_add_u32 s3, s3, s4
    s_sub_u32 s4, 480, s3
    s_cmp_eq_u32 s49, 0
    s_cselect_b32 s50, s3, s4
    s_mul_i32 s51, s44, 12288
    s_add_u32 s51, s51, 114688
    s_lshl_b32 s52, s50, 1
    s_and_b32 s3, s46, 7
    s_mul_i32 s53, s3, 81920
    s_add_u32 s53, s53, s52
    s_add_u32 s54, s52, 704512
    v_lshrrev_b32 v5, 2, v1
    v_and_b32 v2, 3, v1
    v_lshlrev_b32 v2, 4, v2
    v_lshl_add_u32 v4, v5, 10, v2
    v_bfe_u32 v2, v1, 2, 2
    v_lshrrev_b32 v3, 5, v1
    v_lshl_add_u32 v2, v3, 3, v2
    v_lshlrev_b32 v12, 6, v2
    v_bfe_u32 v2, v1, 4, 1
    v_lshl_add_u32 v12, v2, 5, v12
    v_and_b32 v2, 3, v1
    v_lshl_add_u32 v12, v2, 3, v12
    v_add_u32 v12, s51, v12
    s_waitcnt vmcnt(15)
    v_mfma_f32_16x16x32_bf16 v[48:51], v[96:99], v[128:131], 0
    v_lshlrev_b32 v20, 16, v14
    v_mfma_f32_16x16x32_bf16 v[52:55], v[96:99], v[160:163], 0
    v_mfma_f32_16x16x32_bf16 v[56:59], v[96:99], v[192:195], 0
    v_and_b32 v21, 0xffff0000, v14
    ds_write_b128 v9, v[32:35] offset:0
    v_mfma_f32_16x16x32_bf16 v[60:63], v[96:99], v[224:227], 0
    v_permlane32_swap_b32 v16, v18
    v_mfma_f32_16x16x32_bf16 v[48:51], v[100:103], v[132:135], v[48:51]
    s_add_u32 m0, s51, 0
    s_nop 0
    buffer_load_dwordx4 v4, s[36:39], s53 offen lds
    s_add_u32 s53, s53, 16384
    s_cmp_eq_u32 s53, s54
    s_cselect_b32 s53, s52, s53
    v_mfma_f32_16x16x32_bf16 v[52:55], v[100:103], v[164:167], v[52:55]
    v_permlane32_swap_b32 v17, v19
    ds_write_b128 v9, v[36:39] offset:1024
    v_mfma_f32_16x16x32_bf16 v[56:59], v[100:103], v[196:199], v[56:59]
    v_add_f32 v16, v16, v18
    s_add_u32 m0, s51, 1024
    s_nop 0
    buffer_load_dwordx4 v4, s[36:39], s53 offen lds
    s_add_u32 s53, s53, 16384
    s_cmp_eq_u32 s53, s54
    s_cselect_b32 s53, s52, s53
    v_mfma_f32_16x16x32_bf16 v[60:63], v[100:103], v[228:231], v[60:63]
    ds_write_b128 v9, v[40:43] offset:2048
    s_waitcnt vmcnt(15)
    v_mfma_f32_16x16x32_bf16 v[48:51], v[104:107], v[136:139], v[48:51]
    v_add_f32 v17, v17, v19
    s_add_u32 m0, s51, 2048
    s_nop 0
    buffer_load_dwordx4 v4, s[36:39], s53 offen lds
    s_add_u32 s53, s53, 16384
    s_cmp_eq_u32 s53, s54
    s_cselect_b32 s53, s52, s53
    v_mfma_f32_16x16x32_bf16 v[52:55], v[104:107], v[168:171], v[52:55]
    v_add_f32 v16, v16, v15
    v_mfma_f32_16x16x32_bf16 v[56:59], v[104:107], v[200:203], v[56:59]
    v_add_f32 v17, v17, v15
    ds_write_b128 v9, v[44:47] offset:3072
    s_add_u32 m0, s51, 3072
    s_nop 0
    buffer_load_dwordx4 v4, s[36:39], s53 offen lds
    s_add_u32 s53, s53, 16384
    s_cmp_eq_u32 s53, s54
    s_cselect_b32 s53, s52, s53
    v_mfma_f32_16x16x32_bf16 v[60:63], v[104:107], v[232:235], v[60:63]
    v_mul_f32 v16, v16, v20
    v_mfma_f32_16x16x32_bf16 v[48:51], v[108:111], v[140:143], v[48:51]
    v_mfma_f32_16x16x32_bf16 v[52:55], v[108:111], v[172:175], v[52:55]
    v_mul_f32 v17, v17, v21
    s_add_u32 m0, s51, 4096
    s_nop 0
    buffer_load_dwordx4 v4, s[36:39], s53 offen lds
    s_add_u32 s53, s53, 16384
    s_cmp_eq_u32 s53, s54
    s_cselect_b32 s53, s52, s53
    v_mfma_f32_16x16x32_bf16 v[56:59], v[108:111], v[204:207], v[56:59]
    v_cvt_pk_bf16_f32 v6, v16, v17
    v_mfma_f32_16x16x32_bf16 v[60:63], v[108:111], v[236:239], v[60:63]
    s_lshl_b32 s4, s57, 5
    s_and_b32 s4, s4, 0xff
    s_add_u32 m0, s51, 5120
    s_nop 0
    buffer_load_dwordx4 v4, s[36:39], s53 offen lds
    s_add_u32 s53, s53, 16384
    s_cmp_eq_u32 s53, s54
    s_cselect_b32 s53, s52, s53
    s_waitcnt vmcnt(17)
    v_mfma_f32_16x16x32_bf16 v[48:51], v[112:115], v[144:147], v[48:51]
    s_waitcnt lgkmcnt(0)
    s_barrier
    v_xor_b32 v14, s4, v11
    ds_read_b128 v[16:19], v8 offset:0
    v_mfma_f32_16x16x32_bf16 v[52:55], v[112:115], v[176:179], v[52:55]
    ds_read_b128 v[20:23], v8 offset:4096
    ds_read_b128 v[24:27], v8 offset:8192
    s_add_u32 m0, s51, 6144
    s_nop 0
    buffer_load_dwordx4 v4, s[36:39], s53 offen lds
    s_add_u32 s53, s53, 16384
    s_cmp_eq_u32 s53, s54
    s_cselect_b32 s53, s52, s53
    v_mfma_f32_16x16x32_bf16 v[56:59], v[112:115], v[208:211], v[56:59]
    ds_read_b128 v[28:31], v8 offset:12288
    ds_read_b32 v14, v14
    v_mfma_f32_16x16x32_bf16 v[60:63], v[112:115], v[240:243], v[60:63]
    s_add_u32 m0, s51, 7168
    s_nop 0
    buffer_load_dwordx4 v4, s[36:39], s53 offen lds
    s_add_u32 s53, s53, 16384
    s_cmp_eq_u32 s53, s54
    s_cselect_b32 s53, s52, s53
    v_mfma_f32_16x16x32_bf16 v[48:51], v[116:119], v[148:151], v[48:51]
    v_mfma_f32_16x16x32_bf16 v[52:55], v[116:119], v[180:183], v[52:55]
    v_mfma_f32_16x16x32_bf16 v[56:59], v[116:119], v[212:215], v[56:59]
    s_add_u32 m0, s51, 8192
    s_nop 0
    buffer_load_dwordx4 v4, s[36:39], s53 offen lds
    s_add_u32 s53, s53, 16384
    s_cmp_eq_u32 s53, s54
    s_cselect_b32 s53, s52, s53
    v_mfma_f32_16x16x32_bf16 v[60:63], v[116:119], v[244:247], v[60:63]
    s_waitcnt lgkmcnt(0)
    s_waitcnt vmcnt(18)
    v_mfma_f32_16x16x32_bf16 v[48:51], v[120:123], v[152:155], v[48:51]
    v_add_f32 v16, v16, v20
    s_add_u32 m0, s51, 9216
    s_nop 0
    buffer_load_dwordx4 v4, s[36:39], s53 offen lds
    s_add_u32 s53, s53, 16384
    s_cmp_eq_u32 s53, s54
    s_cselect_b32 s53, s52, s53
    v_mfma_f32_16x16x32_bf16 v[52:55], v[120:123], v[184:187], v[52:55]
    v_add_f32 v24, v24, v28
    v_add_f32 v17, v17, v21
    v_mfma_f32_16x16x32_bf16 v[56:59], v[120:123], v[216:219], v[56:59]
    v_add_f32 v25, v25, v29
    s_add_u32 m0, s51, 10240
    s_nop 0
    buffer_load_dwordx4 v4, s[36:39], s53 offen lds
    s_add_u32 s53, s53, 16384
    s_cmp_eq_u32 s53, s54
    s_cselect_b32 s53, s52, s53
    v_mfma_f32_16x16x32_bf16 v[60:63], v[120:123], v[248:251], v[60:63]
    v_add_f32 v18, v18, v22
    v_add_f32 v26, v26, v30
    v_mfma_f32_16x16x32_bf16 v[48:51], v[124:127], v[156:159], v[48:51]
    v_add_f32 v19, v19, v23
    s_add_u32 m0, s51, 11264
    s_nop 0
    buffer_load_dwordx4 v4, s[36:39], s53 offen lds
    s_add_u32 s53, s53, 16384
    s_cmp_eq_u32 s53, s54
    s_cselect_b32 s53, s52, s53
    v_mfma_f32_16x16x32_bf16 v[52:55], v[124:127], v[188:191], v[52:55]
    v_add_f32 v27, v27, v31
    v_add_f32 v16, v16, v24
    v_mfma_f32_16x16x32_bf16 v[56:59], v[124:127], v[220:223], v[56:59]
    v_add_f32 v17, v17, v25
    v_mfma_f32_16x16x32_bf16 v[60:63], v[124:127], v[252:255], v[60:63]
    v_add_f32 v18, v18, v26
    v_add_f32 v19, v19, v27
    s_waitcnt vmcnt(19)
    v_mfma_f32_16x16x32_bf16 v[32:35], v[64:67], v[128:131], 0
    v_lshlrev_b32 v20, 16, v14
    v_mfma_f32_16x16x32_bf16 v[36:39], v[64:67], v[160:163], 0
    v_mfma_f32_16x16x32_bf16 v[40:43], v[64:67], v[192:195], 0
    v_and_b32 v21, 0xffff0000, v14
    v_permlane32_swap_b32 v16, v18
    ds_write_b128 v9, v[48:51] offset:32768
    v_mfma_f32_16x16x32_bf16 v[44:47], v[64:67], v[224:227], 0
    v_permlane32_swap_b32 v17, v19
    v_mfma_f32_16x16x32_bf16 v[32:35], v[68:71], v[132:135], v[32:35]
    v_mfma_f32_16x16x32_bf16 v[36:39], v[68:71], v[164:167], v[36:39]
    v_add_f32 v16, v16, v18
    v_add_f32 v17, v17, v19
    ds_write_b128 v9, v[52:55] offset:33792
    v_mfma_f32_16x16x32_bf16 v[40:43], v[68:71], v[196:199], v[40:43]
    v_add_f32 v16, v16, v15
    v_mfma_f32_16x16x32_bf16 v[44:47], v[68:71], v[228:231], v[44:47]
    ds_write_b128 v9, v[56:59] offset:34816
    s_waitcnt vmcnt(16)
    v_mfma_f32_16x16x32_bf16 v[32:35], v[72:75], v[136:139], v[32:35]
    v_add_f32 v17, v17, v15
    v_mul_f32 v16, v16, v20
    s_waitcnt vmcnt(11)
    ds_read_b64_tr_b16 v[96:97], v12 offset:0
    ds_read_b64_tr_b16 v[98:99], v12 offset:256
    v_mfma_f32_16x16x32_bf16 v[36:39], v[72:75], v[168:171], v[36:39]
    v_mul_f32 v17, v17, v21
    v_mfma_f32_16x16x32_bf16 v[40:43], v[72:75], v[200:203], v[40:43]
    v_cvt_pk_bf16_f32 v7, v16, v17
    v_mov_b32 v18, s56
    ds_write_b128 v9, v[60:63] offset:35840
    s_waitcnt vmcnt(10)
    ds_read_b64_tr_b16 v[100:101], v12 offset:1024
    ds_read_b64_tr_b16 v[102:103], v12 offset:1280
    v_mfma_f32_16x16x32_bf16 v[44:47], v[72:75], v[232:235], v[44:47]
    v_mov_b32 v19, s57
    v_mfma_f32_16x16x32_bf16 v[32:35], v[76:79], v[140:143], v[32:35]
    v_mfma_f32_16x16x32_bf16 v[36:39], v[76:79], v[172:175], v[36:39]
    v_cndmask_b32 v18, v18, v19, s[84:85]
    v_lshl_add_u32 v18, v18, 10, v13
    s_waitcnt vmcnt(9)
    ds_read_b64_tr_b16 v[104:105], v12 offset:2048
    ds_read_b64_tr_b16 v[106:107], v12 offset:2304
    v_mfma_f32_16x16x32_bf16 v[40:43], v[76:79], v[204:207], v[40:43]
    v_permlane32_swap_b32 v6, v7
    buffer_store_dwordx2 v[6:7], v18, s[16:19], s78 offen sc1
    v_mfma_f32_16x16x32_bf16 v[44:47], v[76:79], v[236:239], v[44:47]
    s_lshl_b32 s4, s58, 5
    s_and_b32 s4, s4, 0xff
    s_waitcnt vmcnt(15)
    v_mfma_f32_16x16x32_bf16 v[32:35], v[80:83], v[144:147], v[32:35]
    s_waitcnt lgkmcnt(4)
    s_barrier
    v_xor_b32 v14, s4, v11
    ds_read_b128 v[16:19], v8 offset:32768
    s_waitcnt vmcnt(9)
    ds_read_b64_tr_b16 v[108:109], v12 offset:3072
    ds_read_b64_tr_b16 v[110:111], v12 offset:3328
    s_waitcnt lgkmcnt(8)
    s_add_u32 m0, s51, 0
    s_nop 0
    buffer_load_dwordx4 v4, s[36:39], s53 offen lds
    s_add_u32 s53, s53, 16384
    s_cmp_eq_u32 s53, s54
    s_cselect_b32 s53, s52, s53
    v_mfma_f32_16x16x32_bf16 v[36:39], v[80:83], v[176:179], v[36:39]
    ds_read_b128 v[20:23], v8 offset:36864
    ds_read_b128 v[24:27], v8 offset:40960
    v_mfma_f32_16x16x32_bf16 v[40:43], v[80:83], v[208:211], v[40:43]
    ds_read_b128 v[28:31], v8 offset:45056
    ds_read_b32 v14, v14
    v_mfma_f32_16x16x32_bf16 v[44:47], v[80:83], v[240:243], v[44:47]
    s_waitcnt vmcnt(9)
    ds_read_b64_tr_b16 v[112:113], v12 offset:4096
    ds_read_b64_tr_b16 v[114:115], v12 offset:4352
    s_waitcnt lgkmcnt(11)
    s_add_u32 m0, s51, 1024
    s_nop 0
    buffer_load_dwordx4 v4, s[36:39], s53 offen lds
    s_add_u32 s53, s53, 16384
    s_cmp_eq_u32 s53, s54
    s_cselect_b32 s53, s52, s53
    v_mfma_f32_16x16x32_bf16 v[32:35], v[84:87], v[148:151], v[32:35]
    v_mfma_f32_16x16x32_bf16 v[36:39], v[84:87], v[180:183], v[36:39]
    v_mfma_f32_16x16x32_bf16 v[40:43], v[84:87], v[212:215], v[40:43]
    s_waitcnt lgkmcnt(2)
    v_add_f32 v16, v16, v20
    s_waitcnt vmcnt(9)
    ds_read_b64_tr_b16 v[116:117], v12 offset:5120
    ds_read_b64_tr_b16 v[118:119], v12 offset:5376
    s_waitcnt lgkmcnt(11)
    s_add_u32 m0, s51, 2048
    s_nop 0
    buffer_load_dwordx4 v4, s[36:39], s53 offen lds
    s_add_u32 s53, s53, 16384
    s_cmp_eq_u32 s53, s54
    s_cselect_b32 s53, s52, s53
    v_mfma_f32_16x16x32_bf16 v[44:47], v[84:87], v[244:247], v[44:47]
    v_add_f32 v24, v24, v28
    v_add_f32 v17, v17, v21
    s_waitcnt vmcnt(16)
    v_mfma_f32_16x16x32_bf16 v[32:35], v[88:91], v[152:155], v[32:35]
    v_add_f32 v25, v25, v29
    v_add_f32 v18, v18, v22
    v_add_f32 v26, v26, v30
    v_mfma_f32_16x16x32_bf16 v[36:39], v[88:91], v[184:187], v[36:39]
    v_add_f32 v19, v19, v23
    v_add_f32 v27, v27, v31
    s_waitcnt vmcnt(9)
    ds_read_b64_tr_b16 v[120:121], v12 offset:6144
    ds_read_b64_tr_b16 v[122:123], v12 offset:6400
    s_waitcnt lgkmcnt(10)
    s_add_u32 m0, s51, 3072
    s_nop 0
    buffer_load_dwordx4 v4, s[36:39], s53 offen lds
    s_add_u32 s53, s53, 16384
    s_cmp_eq_u32 s53, s54
    s_cselect_b32 s53, s52, s53
    v_mfma_f32_16x16x32_bf16 v[40:43], v[88:91], v[216:219], v[40:43]
    v_add_f32 v16, v16, v24
    v_add_f32 v17, v17, v25
    v_add_f32 v18, v18, v26
    v_mfma_f32_16x16x32_bf16 v[44:47], v[88:91], v[248:251], v[44:47]
    v_add_f32 v19, v19, v27
    v_lshlrev_b32 v20, 16, v14
    v_mfma_f32_16x16x32_bf16 v[32:35], v[92:95], v[156:159], v[32:35]
    v_and_b32 v21, 0xffff0000, v14
    v_permlane32_swap_b32 v16, v18
    s_waitcnt vmcnt(9)
    ds_read_b64_tr_b16 v[124:125], v12 offset:7168
    ds_read_b64_tr_b16 v[126:127], v12 offset:7424
    s_waitcnt lgkmcnt(6)
    s_add_u32 m0, s51, 4096
    s_nop 0
    buffer_load_dwordx4 v4, s[36:39], s53 offen lds
    s_add_u32 s53, s53, 16384
    s_cmp_eq_u32 s53, s54
    s_cselect_b32 s53, s52, s53
    v_mfma_f32_16x16x32_bf16 v[36:39], v[92:95], v[188:191], v[36:39]
    v_permlane32_swap_b32 v17, v19
    v_add_f32 v16, v16, v18
    v_add_f32 v17, v17, v19
    v_mfma_f32_16x16x32_bf16 v[40:43], v[92:95], v[220:223], v[40:43]
    v_add_f32 v16, v16, v15
    v_add_f32 v17, v17, v15
    v_mfma_f32_16x16x32_bf16 v[44:47], v[92:95], v[252:255], v[44:47]
    v_mul_f32 v16, v16, v20
    v_mul_f32 v17, v17, v21
    v_cvt_pk_bf16_f32 v6, v16, v17
    ds_write_b128 v9, v[32:35] offset:0
    ds_write_b128 v9, v[36:39] offset:1024
    ds_write_b128 v9, v[40:43] offset:2048
    s_nop 1
    ds_write_b128 v9, v[44:47] offset:3072
    s_waitcnt lgkmcnt(0)
    s_barrier
    s_lshl_b32 s4, s59, 5
    s_and_b32 s4, s4, 0xff
    v_xor_b32 v14, s4, v11
    ds_read_b128 v[16:19], v8 offset:0
    ds_read_b128 v[20:23], v8 offset:4096
    ds_read_b128 v[24:27], v8 offset:8192
    ds_read_b128 v[28:31], v8 offset:12288
    ds_read_b32 v14, v14
    s_waitcnt lgkmcnt(0)
    v_add_f32 v16, v16, v20
    v_add_f32 v24, v24, v28
    v_add_f32 v17, v17, v21
    v_add_f32 v25, v25, v29
    v_add_f32 v18, v18, v22
    v_add_f32 v26, v26, v30
    v_add_f32 v19, v19, v23
    v_add_f32 v27, v27, v31
    v_add_f32 v16, v16, v24
    v_add_f32 v17, v17, v25
    v_add_f32 v18, v18, v26
    v_add_f32 v19, v19, v27
    v_lshlrev_b32 v20, 16, v14
    v_and_b32 v21, 0xffff0000, v14
    v_permlane32_swap_b32 v16, v18
    v_permlane32_swap_b32 v17, v19
    v_add_f32 v16, v16, v18
    v_add_f32 v17, v17, v19
    v_add_f32 v16, v16, v15
    v_add_f32 v17, v17, v15
    v_mul_f32 v16, v16, v20
    v_mul_f32 v17, v17, v21
    v_cvt_pk_bf16_f32 v7, v16, v17
    v_mov_b32 v18, s58
    v_mov_b32 v19, s59
    v_cndmask_b32 v18, v18, v19, s[84:85]
    v_lshl_add_u32 v18, v18, 10, v13
    v_permlane32_swap_b32 v6, v7
    buffer_store_dwordx2 v[6:7], v18, s[16:19], s78 offen sc1
    s_waitcnt vmcnt(10)
    ds_read_b64_tr_b16 v[128:129], v12 offset:8192
    ds_read_b64_tr_b16 v[130:131], v12 offset:8448
    s_waitcnt lgkmcnt(15)
    s_add_u32 m0, s51, 5120
    s_nop 0
    buffer_load_dwordx4 v4, s[36:39], s53 offen lds
    s_add_u32 s53, s53, 16384
    s_cmp_eq_u32 s53, s54
    s_cselect_b32 s53, s52, s53
    s_waitcnt vmcnt(10)
    ds_read_b64_tr_b16 v[132:133], v12 offset:9216
    ds_read_b64_tr_b16 v[134:135], v12 offset:9472
    s_waitcnt lgkmcnt(15)
    s_add_u32 m0, s51, 6144
    s_nop 0
    buffer_load_dwordx4 v4, s[36:39], s53 offen lds
    s_add_u32 s53, s53, 16384
    s_cmp_eq_u32 s53, s54
    s_cselect_b32 s53, s52, s53
    s_waitcnt vmcnt(10)
    ds_read_b64_tr_b16 v[136:137], v12 offset:10240
    ds_read_b64_tr_b16 v[138:139], v12 offset:10496
    s_waitcnt lgkmcnt(15)
    s_add_u32 m0, s51, 7168
    s_nop 0
    buffer_load_dwordx4 v4, s[36:39], s53 offen lds
    s_add_u32 s53, s53, 16384
    s_cmp_eq_u32 s53, s54
    s_cselect_b32 s53, s52, s53
    s_waitcnt vmcnt(10)
    ds_read_b64_tr_b16 v[140:141], v12 offset:11264
    ds_read_b64_tr_b16 v[142:143], v12 offset:11520
    s_waitcnt lgkmcnt(6)
    s_add_u32 m0, s51, 8192
    s_nop 0
    buffer_load_dwordx4 v4, s[36:39], s53 offen lds
    s_add_u32 s53, s53, 16384
    s_cmp_eq_u32 s53, s54
    s_cselect_b32 s53, s52, s53
    s_waitcnt vmcnt(9)
    ds_read_b64_tr_b16 v[144:145], v12 offset:0
    ds_read_b64_tr_b16 v[146:147], v12 offset:256
    s_waitcnt lgkmcnt(6)
    s_add_u32 m0, s51, 9216
    s_nop 0
    buffer_load_dwordx4 v4, s[36:39], s53 offen lds
    s_add_u32 s53, s53, 16384
    s_cmp_eq_u32 s53, s54
    s_cselect_b32 s53, s52, s53
    s_waitcnt vmcnt(9)
    ds_read_b64_tr_b16 v[148:149], v12 offset:1024
    ds_read_b64_tr_b16 v[150:151], v12 offset:1280
    s_waitcnt lgkmcnt(6)
    s_add_u32 m0, s51, 10240
    s_nop 0
    buffer_load_dwordx4 v4, s[36:39], s53 offen lds
    s_add_u32 s53, s53, 16384
    s_cmp_eq_u32 s53, s54
    s_cselect_b32 s53, s52, s53
    s_waitcnt vmcnt(9)
    ds_read_b64_tr_b16 v[152:153], v12 offset:2048
    ds_read_b64_tr_b16 v[154:155], v12 offset:2304
    s_waitcnt lgkmcnt(6)
    s_add_u32 m0, s51, 11264
    s_nop 0
    buffer_load_dwordx4 v4, s[36:39], s53 offen lds
    s_add_u32 s53, s53, 16384
    s_cmp_eq_u32 s53, s54
    s_cselect_b32 s53, s52, s53
    s_waitcnt vmcnt(9)
    ds_read_b64_tr_b16 v[156:157], v12 offset:3072
    ds_read_b64_tr_b16 v[158:159], v12 offset:3328
    s_waitcnt lgkmcnt(6)
    s_add_u32 m0, s51, 0
    s_nop 0
    buffer_load_dwordx4 v4, s[36:39], s53 offen lds
    s_add_u32 s53, s53, 16384
    s_cmp_eq_u32 s53, s54
    s_cselect_b32 s53, s52, s53
    s_waitcnt vmcnt(9)
    ds_read_b64_tr_b16 v[160:161], v12 offset:4096
    ds_read_b64_tr_b16 v[162:163], v12 offset:4352
    s_waitcnt lgkmcnt(6)
    s_add_u32 m0, s51, 1024
    s_nop 0
    buffer_load_dwordx4 v4, s[36:39], s53 offen lds
    s_add_u32 s53, s53, 16384
    s_cmp_eq_u32 s53, s54
    s_cselect_b32 s53, s52, s53
    s_waitcnt vmcnt(9)
    s_barrier
    s_cmp_lg_u32 s44, 0
    s_cbranch_scc1 L_soft_p3_f
    s_and_b32 s3, s2, 1
    s_lshl_b32 s3, s3, 2
    s_lshr_b32 s4, s2, 6
    s_add_u32 s3, s3, s4
    s_lshl_b32 s3, s3, 2
    s_lshl_b32 s4, s64, 8
    s_add_u32 s3, s3, s4
    s_add_u32 s3, s3, 14745600
    v_mul_u32_u24 v2, 0, v1
    v_cmp_gt_u32 vcc, 1, v1
    v_mov_b32 v3, 0x40000000
    s_nop 0
    v_cndmask_b32 v2, v3, v2, vcc
    v_mov_b32 v3, s45
    buffer_store_dword v3, v2, s[16:19], s3 offen sc1
L_soft_p3_f:
    v_and_b32 v10, 31, v1
    v_lshrrev_b32 v11, 5, v1
    v_lshlrev_b32 v7, 18, v11
    v_lshl_add_u32 v7, v10, 1, v7
    s_lshl_b32 s3, s46, 10
    s_add_u32 s55, s3, s52
    v_lshlrev_b32 v9, 9, v11
    v_lshl_add_u32 v9, v10, 3, v9
    v_sub_u32 v5, 31, v10
    s_cmp_eq_u32 s49, 0
    s_cselect_b64 vcc, -1, 0
    v_cndmask_b32 v5, v5, v10, vcc
    v_lshl_add_u32 v5, v11, 5, v5
    s_lshl_b32 s3, s48, 12
    s_add_u32 s3, s3, 45056
    v_lshl_add_u32 v8, v5, 4, s3
    s_cmp_eq_u32 s49, 0
    s_cselect_b32 s56, 1.0, -1.0
    s_waitcnt vmcnt(8)
    ds_read_b64_tr_b16 v[164:165], v12 offset:5120
    ds_read_b64_tr_b16 v[166:167], v12 offset:5376
    s_waitcnt lgkmcnt(6)
    s_add_u32 m0, s51, 2048
    s_nop 0
    buffer_load_dwordx4 v4, s[36:39], s53 offen lds
    s_add_u32 s53, s53, 16384
    s_cmp_eq_u32 s53, s54
    s_cselect_b32 s53, s52, s53
    s_waitcnt vmcnt(8)
    ds_read_b64_tr_b16 v[168:169], v12 offset:6144
    ds_read_b64_tr_b16 v[170:171], v12 offset:6400
    s_waitcnt lgkmcnt(6)
    s_add_u32 m0, s51, 3072
    s_nop 0
    buffer_load_dwordx4 v4, s[36:39], s53 offen lds
    s_add_u32 s53, s53, 16384
    s_cmp_eq_u32 s53, s54
    s_cselect_b32 s53, s52, s53
    s_waitcnt vmcnt(8)
    ds_read_b64_tr_b16 v[172:173], v12 offset:7168
    ds_read_b64_tr_b16 v[174:175], v12 offset:7424
    s_waitcnt lgkmcnt(6)
    s_add_u32 m0, s51, 4096
    s_nop 0
    buffer_load_dwordx4 v4, s[36:39], s53 offen lds
    s_add_u32 s53, s53, 16384
    s_cmp_eq_u32 s53, s54
    s_cselect_b32 s53, s52, s53
    s_waitcnt vmcnt(8)
    ds_read_b64_tr_b16 v[176:177], v12 offset:8192
    ds_read_b64_tr_b16 v[178:179], v12 offset:8448
    s_waitcnt lgkmcnt(6)
    s_add_u32 m0, s51, 5120
    s_nop 0
    buffer_load_dwordx4 v4, s[36:39], s53 offen lds
    s_add_u32 s53, s53, 16384
    s_cmp_eq_u32 s53, s54
    s_cselect_b32 s53, s52, s53
    s_waitcnt vmcnt(8)
    ds_read_b64_tr_b16 v[180:181], v12 offset:9216
    ds_read_b64_tr_b16 v[182:183], v12 offset:9472
    s_waitcnt lgkmcnt(6)
    s_add_u32 m0, s51, 6144
    s_nop 0
    buffer_load_dwordx4 v4, s[36:39], s53 offen lds
    s_add_u32 s53, s53, 16384
    s_cmp_eq_u32 s53, s54
    s_cselect_b32 s53, s52, s53
    s_waitcnt vmcnt(8)
    ds_read_b64_tr_b16 v[184:185], v12 offset:10240
    ds_read_b64_tr_b16 v[186:187], v12 offset:10496
    s_waitcnt lgkmcnt(6)
    s_add_u32 m0, s51, 7168
    s_nop 0
    buffer_load_dwordx4 v4, s[36:39], s53 offen lds
    s_add_u32 s53, s53, 16384
    s_cmp_eq_u32 s53, s54
    s_cselect_b32 s53, s52, s53
    s_waitcnt vmcnt(8)
    ds_read_b64_tr_b16 v[188:189], v12 offset:11264
    ds_read_b64_tr_b16 v[190:191], v12 offset:11520
    s_waitcnt lgkmcnt(6)
    s_add_u32 m0, s51, 8192
    s_nop 0
    buffer_load_dwordx4 v4, s[36:39], s53 offen lds
    s_add_u32 s53, s53, 16384
    s_cmp_eq_u32 s53, s54
    s_cselect_b32 s53, s52, s53
    s_waitcnt vmcnt(8)
    ds_read_b64_tr_b16 v[192:193], v12 offset:0
    ds_read_b64_tr_b16 v[194:195], v12 offset:256
    s_waitcnt lgkmcnt(6)
    s_add_u32 m0, s51, 9216
    s_nop 0
    buffer_load_dwordx4 v4, s[36:39], s53 offen lds
    s_add_u32 s53, s53, 16384
    s_cmp_eq_u32 s53, s54
    s_cselect_b32 s53, s52, s53
    s_waitcnt vmcnt(8)
    ds_read_b64_tr_b16 v[196:197], v12 offset:1024
    ds_read_b64_tr_b16 v[198:199], v12 offset:1280
    s_waitcnt lgkmcnt(6)
    s_add_u32 m0, s51, 10240
    s_nop 0
    buffer_load_dwordx4 v4, s[36:39], s53 offen lds
    s_add_u32 s53, s53, 16384
    s_cmp_eq_u32 s53, s54
    s_cselect_b32 s53, s52, s53
    s_waitcnt vmcnt(8)
    ds_read_b64_tr_b16 v[200:201], v12 offset:2048
    ds_read_b64_tr_b16 v[202:203], v12 offset:2304
    s_waitcnt lgkmcnt(6)
    s_add_u32 m0, s51, 11264
    s_nop 0
    buffer_load_dwordx4 v4, s[36:39], s53 offen lds
    s_add_u32 s53, s53, 16384
    s_cmp_eq_u32 s53, s54
    s_cselect_b32 s53, s52, s53
    s_waitcnt vmcnt(8)
    ds_read_b64_tr_b16 v[204:205], v12 offset:3072
    ds_read_b64_tr_b16 v[206:207], v12 offset:3328
    s_waitcnt lgkmcnt(6)
    s_add_u32 m0, s51, 0
    s_nop 0
    buffer_load_dwordx4 v4, s[36:39], s53 offen lds
    s_add_u32 s53, s53, 16384
    s_cmp_eq_u32 s53, s54
    s_cselect_b32 s53, s52, s53
    s_waitcnt vmcnt(8)
    ds_read_b64_tr_b16 v[208:209], v12 offset:4096
    ds_read_b64_tr_b16 v[210:211], v12 offset:4352
    s_waitcnt lgkmcnt(6)
    s_add_u32 m0, s51, 1024
    s_nop 0
    buffer_load_dwordx4 v4, s[36:39], s53 offen lds
    s_add_u32 s53, s53, 16384
    s_cmp_eq_u32 s53, s54
    s_cselect_b32 s53, s52, s53
    s_waitcnt vmcnt(8)
    ds_read_b64_tr_b16 v[212:213], v12 offset:5120
    ds_read_b64_tr_b16 v[214:215], v12 offset:5376
    s_waitcnt lgkmcnt(6)
    s_add_u32 m0, s51, 2048
    s_nop 0
    buffer_load_dwordx4 v4, s[36:39], s53 offen lds
    s_add_u32 s53, s53, 16384
    s_cmp_eq_u32 s53, s54
    s_cselect_b32 s53, s52, s53
    s_waitcnt vmcnt(8)
    ds_read_b64_tr_b16 v[216:217], v12 offset:6144
    ds_read_b64_tr_b16 v[218:219], v12 offset:6400
    s_waitcnt lgkmcnt(6)
    s_add_u32 m0, s51, 3072
    s_nop 0
    buffer_load_dwordx4 v4, s[36:39], s53 offen lds
    s_add_u32 s53, s53, 16384
    s_cmp_eq_u32 s53, s54
    s_cselect_b32 s53, s52, s53
    s_waitcnt vmcnt(8)
    ds_read_b64_tr_b16 v[220:221], v12 offset:7168
    ds_read_b64_tr_b16 v[222:223], v12 offset:7424
    s_waitcnt lgkmcnt(6)
    s_add_u32 m0, s51, 4096
    s_nop 0
    buffer_load_dwordx4 v4, s[36:39], s53 offen lds
    s_add_u32 s53, s53, 16384
    s_cmp_eq_u32 s53, s54
    s_cselect_b32 s53, s52, s53
    s_waitcnt vmcnt(8)
    ds_read_b64_tr_b16 v[224:225], v12 offset:8192
    ds_read_b64_tr_b16 v[226:227], v12 offset:8448
    s_waitcnt lgkmcnt(6)
    s_add_u32 m0, s51, 5120
    s_nop 0
    buffer_load_dwordx4 v4, s[36:39], s53 offen lds
    s_add_u32 s53, s53, 16384
    s_cmp_eq_u32 s53, s54
    s_cselect_b32 s53, s52, s53
    s_waitcnt vmcnt(8)
    ds_read_b64_tr_b16 v[228:229], v12 offset:9216
    ds_read_b64_tr_b16 v[230:231], v12 offset:9472
    s_waitcnt lgkmcnt(6)
    s_add_u32 m0, s51, 6144
    s_nop 0
    buffer_load_dwordx4 v4, s[36:39], s53 offen lds
    s_add_u32 s53, s53, 16384
    s_cmp_eq_u32 s53, s54
    s_cselect_b32 s53, s52, s53
    s_add_u32 s3, s55, 0
    buffer_load_ushort v32, v7, s[8:11], s3 offen
    s_add_u32 s3, s55, 65536
    buffer_load_ushort v33, v7, s[8:11], s3 offen
    s_add_u32 s3, s55, 131072
    buffer_load_ushort v34, v7, s[8:11], s3 offen
    s_add_u32 s3, s55, 196608
    buffer_load_ushort v35, v7, s[8:11], s3 offen
    s_add_u32 s3, s55, 524288
    buffer_load_ushort v36, v7, s[8:11], s3 offen
    s_add_u32 s3, s55, 589824
    buffer_load_ushort v37, v7, s[8:11], s3 offen
    s_add_u32 s3, s55, 655360
    buffer_load_ushort v38, v7, s[8:11], s3 offen
    s_add_u32 s3, s55, 720896
    buffer_load_ushort v39, v7, s[8:11], s3 offen
    s_add_u32 s3, s55, 1048576
    buffer_load_ushort v40, v7, s[8:11], s3 offen
    s_add_u32 s3, s55, 1114112
    buffer_load_ushort v41, v7, s[8:11], s3 offen
    s_add_u32 s3, s55, 1179648
    buffer_load_ushort v42, v7, s[8:11], s3 offen
    s_add_u32 s3, s55, 1245184
    buffer_load_ushort v43, v7, s[8:11], s3 offen
    s_add_u32 s3, s55, 1572864
    buffer_load_ushort v44, v7, s[8:11], s3 offen
    s_add_u32 s3, s55, 1638400
    buffer_load_ushort v45, v7, s[8:11], s3 offen
    s_add_u32 s3, s55, 1703936
    buffer_load_ushort v46, v7, s[8:11], s3 offen
    s_add_u32 s3, s55, 1769472
    buffer_load_ushort v47, v7, s[8:11], s3 offen
    s_waitcnt vmcnt(24)
    ds_read_b64_tr_b16 v[232:233], v12 offset:10240
    ds_read_b64_tr_b16 v[234:235], v12 offset:10496
    s_waitcnt vmcnt(23)
    ds_read_b64_tr_b16 v[236:237], v12 offset:11264
    ds_read_b64_tr_b16 v[238:239], v12 offset:11520
    s_waitcnt vmcnt(22)
    ds_read_b64_tr_b16 v[240:241], v12 offset:0
    ds_read_b64_tr_b16 v[242:243], v12 offset:256
    s_waitcnt vmcnt(21)
    ds_read_b64_tr_b16 v[244:245], v12 offset:1024
    ds_read_b64_tr_b16 v[246:247], v12 offset:1280
    s_waitcnt vmcnt(20)
    ds_read_b64_tr_b16 v[248:249], v12 offset:2048
    ds_read_b64_tr_b16 v[250:251], v12 offset:2304
    s_waitcnt vmcnt(19)
    ds_read_b64_tr_b16 v[252:253], v12 offset:3072
    ds_read_b64_tr_b16 v[254:255], v12 offset:3328
    s_waitcnt vmcnt(18)
    ds_read_b64_tr_b16 v[84:85], v12 offset:4096
    ds_read_b64_tr_b16 v[86:87], v12 offset:4352
    s_waitcnt vmcnt(17)
    ds_read_b64_tr_b16 v[88:89], v12 offset:5120
    ds_read_b64_tr_b16 v[90:91], v12 offset:5376
    s_waitcnt vmcnt(16)
    ds_read_b64_tr_b16 v[92:93], v12 offset:6144
    ds_read_b64_tr_b16 v[94:95], v12 offset:6400
    s_waitcnt vmcnt(0)
    v_lshlrev_b32 v32, 16, v32
    v_lshlrev_b32 v33, 16, v33
    v_lshlrev_b32 v34, 16, v34
    v_lshlrev_b32 v35, 16, v35
    v_lshlrev_b32 v36, 16, v36
    v_lshlrev_b32 v37, 16, v37
    v_lshlrev_b32 v38, 16, v38
    v_lshlrev_b32 v39, 16, v39
    v_lshlrev_b32 v40, 16, v40
    v_lshlrev_b32 v41, 16, v41
    v_lshlrev_b32 v42, 16, v42
    v_lshlrev_b32 v43, 16, v43
    v_lshlrev_b32 v44, 16, v44
    v_lshlrev_b32 v45, 16, v45
    v_lshlrev_b32 v46, 16, v46
    v_lshlrev_b32 v47, 16, v47
    s_cmp_lg_u32 s44, 0
    s_cbranch_scc1 L_soft_p3_h
    v_and_b32 v5, 7, v1
    v_lshlrev_b32 v5, 2, v5
    s_lshr_b32 s3, s46, 1
    s_lshl_b32 s3, s3, 8
    s_add_u32 s5, s3, 14745600
    v_lshlrev_b32 v4, 4, v1
    s_mul_i32 s52, s46, 44032
    s_add_u32 s52, s52, 10485760
    s_and_b32 s3, s46, 7
    s_mul_i32 s53, s3, 5120
    s_add_u32 s53, s53, s52
    s_add_u32 s54, s52, 44032
    s_mov_b32 s61, 0
L_soft_poll2:
    buffer_load_dword v6, v5, s[16:19], s5 offen sc1
    s_waitcnt vmcnt(0)
    v_xor_b32 v2, s45, v6
    v_cmp_ne_u32 vcc, 0, v2
    s_add_u32 s61, s61, 1
    s_cmp_gt_u32 s61, 20000
    s_nop 1
    s_cbranch_scc1 L_soft_pollx2
    s_cbranch_vccnz L_soft_poll2
L_soft_pollx2:
    s_mov_b32 m0, 0
    s_nop 0
    buffer_load_dwordx4 v4, s[16:19], s53 offen lds
    s_add_u32 s53, s53, 1024
    s_cmp_eq_u32 s53, s54
    s_cselect_b32 s53, s52, s53
    s_mov_b32 m0, 1024
    s_nop 0
    buffer_load_dwordx4 v4, s[16:19], s53 offen lds
    s_add_u32 s53, s53, 1024
    s_cmp_eq_u32 s53, s54
    s_cselect_b32 s53, s52, s53
    s_mov_b32 m0, 2048
    s_nop 0
    buffer_load_dwordx4 v4, s[16:19], s53 offen lds
    s_add_u32 s53, s53, 1024
    s_cmp_eq_u32 s53, s54
    s_cselect_b32 s53, s52, s53
    s_mov_b32 m0, 3072
    s_nop 0
    buffer_load_dwordx4 v4, s[16:19], s53 offen lds
    s_add_u32 s53, s53, 1024
    s_cmp_eq_u32 s53, s54
    s_cselect_b32 s53, s52, s53
    s_mov_b32 m0, 4096
    s_nop 0
    buffer_load_dwordx4 v4, s[16:19], s53 offen lds
    s_add_u32 s53, s53, 1024
    s_cmp_eq_u32 s53, s54
    s_cselect_b32 s53, s52, s53
    s_mov_b32 m0, 5120
    s_nop 0
    buffer_load_dwordx4 v4, s[16:19], s53 offen lds
    s_add_u32 s53, s53, 1024
    s_cmp_eq_u32 s53, s54
    s_cselect_b32 s53, s52, s53
    s_mov_b32 m0, 6144
    s_nop 0
    buffer_load_dwordx4 v4, s[16:19], s53 offen lds
    s_add_u32 s53, s53, 1024
    s_cmp_eq_u32 s53, s54
    s_cselect_b32 s53, s52, s53
    s_mov_b32 m0, 7168
    s_nop 0
    buffer_load_dwordx4 v4, s[16:19], s53 offen lds
    s_add_u32 s53, s53, 1024
    s_cmp_eq_u32 s53, s54
    s_cselect_b32 s53, s52, s53
    s_mov_b32 m0, 8192
    s_nop 0
    buffer_load_dwordx4 v4, s[16:19], s53 offen lds
    s_add_u32 s53, s53, 1024
    s_cmp_eq_u32 s53, s54
    s_cselect_b32 s53, s52, s53
    s_mov_b32 m0, 9216
    s_nop 0
    buffer_load_dwordx4 v4, s[16:19], s53 offen lds
    s_add_u32 s53, s53, 1024
    s_cmp_eq_u32 s53, s54
    s_cselect_b32 s53, s52, s53
    s_mov_b32 m0, 10240
    s_nop 0
    buffer_load_dwordx4 v4, s[16:19], s53 offen lds
    s_add_u32 s53, s53, 1024
    s_cmp_eq_u32 s53, s54
    s_cselect_b32 s53, s52, s53
    s_mov_b32 m0, 11264
    s_nop 0
    buffer_load_dwordx4 v4, s[16:19], s53 offen lds
    s_add_u32 s53, s53, 1024
    s_cmp_eq_u32 s53, s54
    s_cselect_b32 s53, s52, s53
    s_mov_b32 m0, 12288
    s_nop 0
    buffer_load_dwordx4 v4, s[16:19], s53 offen lds
    s_add_u32 s53, s53, 1024
    s_cmp_eq_u32 s53, s54
    s_cselect_b32 s53, s52, s53
    s_mov_b32 m0, 13312
    s_nop 0
    buffer_load_dwordx4 v4, s[16:19], s53 offen lds
    s_add_u32 s53, s53, 1024
    s_cmp_eq_u32 s53, s54
    s_cselect_b32 s53, s52, s53
    s_mov_b32 m0, 14336
    s_nop 0
    buffer_load_dwordx4 v4, s[16:19], s53 offen lds
    s_add_u32 s53, s53, 1024
    s_cmp_eq_u32 s53, s54
    s_cselect_b32 s53, s52, s53
    s_mov_b32 m0, 15360
    s_nop 0
    buffer_load_dwordx4 v4, s[16:19], s53 offen lds
    s_add_u32 s53, s53, 1024
    s_cmp_eq_u32 s53, s54
    s_cselect_b32 s53, s52, s53
    s_mov_b32 m0, 16384
    s_nop 0
    buffer_load_dwordx4 v4, s[16:19], s53 offen lds
    s_add_u32 s53, s53, 1024
    s_cmp_eq_u32 s53, s54
    s_cselect_b32 s53, s52, s53
    s_mov_b32 m0, 17408
    s_nop 0
    buffer_load_dwordx4 v4, s[16:19], s53 offen lds
    s_add_u32 s53, s53, 1024
    s_cmp_eq_u32 s53, s54
    s_cselect_b32 s53, s52, s53
    s_mov_b32 m0, 18432
    s_nop 0
    buffer_load_dwordx4 v4, s[16:19], s53 offen lds
    s_add_u32 s53, s53, 1024
    s_cmp_eq_u32 s53, s54
    s_cselect_b32 s53, s52, s53
    s_mov_b32 m0, 19456
    s_nop 0
    buffer_load_dwordx4 v4, s[16:19], s53 offen lds
    s_add_u32 s53, s53, 1024
    s_cmp_eq_u32 s53, s54
    s_cselect_b32 s53, s52, s53
    s_mov_b32 m0, 20480
    s_nop 0
    buffer_load_dwordx4 v4, s[16:19], s53 offen lds
    s_add_u32 s53, s53, 1024
    s_cmp_eq_u32 s53, s54
    s_cselect_b32 s53, s52, s53
    s_mov_b32 m0, 21504
    s_nop 0
    buffer_load_dwordx4 v4, s[16:19], s53 offen lds
    s_add_u32 s53, s53, 1024
    s_cmp_eq_u32 s53, s54
    s_cselect_b32 s53, s52, s53
    s_mov_b32 m0, 22528
    s_nop 0
    buffer_load_dwordx4 v4, s[16:19], s53 offen lds
    s_add_u32 s53, s53, 1024
    s_cmp_eq_u32 s53, s54
    s_cselect_b32 s53, s52, s53
    s_mov_b32 m0, 23552
    s_nop 0
    buffer_load_dwordx4 v4, s[16:19], s53 offen lds
    s_add_u32 s53, s53, 1024
    s_cmp_eq_u32 s53, s54
    s_cselect_b32 s53, s52, s53
    s_mov_b32 m0, 24576
    s_nop 0
    buffer_load_dwordx4 v4, s[16:19], s53 offen lds
    s_add_u32 s53, s53, 1024
    s_cmp_eq_u32 s53, s54
    s_cselect_b32 s53, s52, s53
    s_mov_b32 m0, 25600
    s_nop 0
    buffer_load_dwordx4 v4, s[16:19], s53 offen lds
    s_add_u32 s53, s53, 1024
    s_cmp_eq_u32 s53, s54
    s_cselect_b32 s53, s52, s53
    s_mov_b32 m0, 26624
    s_nop 0
    buffer_load_dwordx4 v4, s[16:19], s53 offen lds
    s_add_u32 s53, s53, 1024
    s_cmp_eq_u32 s53, s54
    s_cselect_b32 s53, s52, s53
    s_mov_b32 m0, 27648
    s_nop 0
    buffer_load_dwordx4 v4, s[16:19], s53 offen lds
    s_add_u32 s53, s53, 1024
    s_cmp_eq_u32 s53, s54
    s_cselect_b32 s53, s52, s53
    s_mov_b32 m0, 28672
    s_nop 0
    buffer_load_dwordx4 v4, s[16:19], s53 offen lds
    s_add_u32 s53, s53, 1024
    s_cmp_eq_u32 s53, s54
    s_cselect_b32 s53, s52, s53
    s_mov_b32 m0, 29696
    s_nop 0
    buffer_load_dwordx4 v4, s[16:19], s53 offen lds
    s_add_u32 s53, s53, 1024
    s_cmp_eq_u32 s53, s54
    s_cselect_b32 s53, s52, s53
    s_mov_b32 m0, 30720
    s_nop 0
    buffer_load_dwordx4 v4, s[16:19], s53 offen lds
    s_add_u32 s53, s53, 1024
    s_cmp_eq_u32 s53, s54
    s_cselect_b32 s53, s52, s53
    s_mov_b32 m0, 31744
    s_nop 0
    buffer_load_dwordx4 v4, s[16:19], s53 offen lds
    s_add_u32 s53, s53, 1024
    s_cmp_eq_u32 s53, s54
    s_cselect_b32 s53, s52, s53
    s_mov_b32 m0, 32768
    s_nop 0
    buffer_load_dwordx4 v4, s[16:19], s53 offen lds
    s_add_u32 s53, s53, 1024
    s_cmp_eq_u32 s53, s54
    s_cselect_b32 s53, s52, s53
    s_mov_b32 m0, 33792
    s_nop 0
    buffer_load_dwordx4 v4, s[16:19], s53 offen lds
    s_add_u32 s53, s53, 1024
    s_cmp_eq_u32 s53, s54
    s_cselect_b32 s53, s52, s53
    s_mov_b32 m0, 34816
    s_nop 0
    buffer_load_dwordx4 v4, s[16:19], s53 offen lds
    s_add_u32 s53, s53, 1024
    s_cmp_eq_u32 s53, s54
    s_cselect_b32 s53, s52, s53
    s_mov_b32 m0, 35840
    s_nop 0
    buffer_load_dwordx4 v4, s[16:19], s53 offen lds
    s_add_u32 s53, s53, 1024
    s_cmp_eq_u32 s53, s54
    s_cselect_b32 s53, s52, s53
    s_mov_b32 m0, 36864
    s_nop 0
    buffer_load_dwordx4 v4, s[16:19], s53 offen lds
    s_add_u32 s53, s53, 1024
    s_cmp_eq_u32 s53, s54
    s_cselect_b32 s53, s52, s53
    s_mov_b32 m0, 37888
    s_nop 0
    buffer_load_dwordx4 v4, s[16:19], s53 offen lds
    s_add_u32 s53, s53, 1024
    s_cmp_eq_u32 s53, s54
    s_cselect_b32 s53, s52, s53
    s_mov_b32 m0, 38912
    s_nop 0
    buffer_load_dwordx4 v4, s[16:19], s53 offen lds
    s_add_u32 s53, s53, 1024
    s_cmp_eq_u32 s53, s54
    s_cselect_b32 s53, s52, s53
    s_mov_b32 m0, 39936
    s_nop 0
    buffer_load_dwordx4 v4, s[16:19], s53 offen lds
    s_add_u32 s53, s53, 1024
    s_cmp_eq_u32 s53, s54
    s_cselect_b32 s53, s52, s53
    s_mov_b32 m0, 40960
    s_nop 0
    buffer_load_dwordx4 v4, s[16:19], s53 offen lds
    s_add_u32 s53, s53, 1024
    s_cmp_eq_u32 s53, s54
    s_cselect_b32 s53, s52, s53
    s_mov_b32 m0, 41984
    s_nop 0
    buffer_load_dwordx4 v4, s[16:19], s53 offen lds
    s_add_u32 s53, s53, 1024
    s_cmp_eq_u32 s53, s54
    s_cselect_b32 s53, s52, s53
    s_mov_b32 m0, 43008
    s_nop 0
    buffer_load_dwordx4 v4, s[16:19], s53 offen lds
    s_add_u32 s53, s53, 1024
    s_cmp_eq_u32 s53, s54
    s_cselect_b32 s53, s52, s53
L_soft_p3_h:
    s_waitcnt vmcnt(31)
    s_barrier
    ds_read_b64 v[48:49], v9 offset:0
    ds_read_b64 v[50:51], v9 offset:256
    ds_read_b64 v[52:53], v9 offset:1024
    ds_read_b64 v[54:55], v9 offset:1280
    ds_read_b64 v[56:57], v9 offset:2048
    ds_read_b64 v[58:59], v9 offset:2304
    ds_read_b64 v[60:61], v9 offset:3072
    ds_read_b64 v[62:63], v9 offset:3328
    s_waitcnt lgkmcnt(6)
    v_mfma_f32_32x32x16_bf16 v[64:79], v[48:51], v[96:99], 0
    ds_read_b64 v[48:49], v9 offset:4096
    ds_read_b64 v[50:51], v9 offset:4352
    s_waitcnt lgkmcnt(6)
    v_mfma_f32_32x32x16_bf16 v[64:79], v[52:55], v[100:103], v[64:79]
    ds_read_b64 v[52:53], v9 offset:5120
    ds_read_b64 v[54:55], v9 offset:5376
    s_waitcnt lgkmcnt(6)
    v_mfma_f32_32x32x16_bf16 v[64:79], v[56:59], v[104:107], v[64:79]
    ds_read_b64 v[56:57], v9 offset:6144
    ds_read_b64 v[58:59], v9 offset:6400
    s_waitcnt lgkmcnt(6)
    v_mfma_f32_32x32x16_bf16 v[64:79], v[60:63], v[108:111], v[64:79]
    ds_read_b64 v[60:61], v9 offset:7168
    ds_read_b64 v[62:63], v9 offset:7424
    s_waitcnt lgkmcnt(6)
    v_mfma_f32_32x32x16_bf16 v[64:79], v[48:51], v[112:115], v[64:79]
    ds_read_b64 v[48:49], v9 offset:8192
    ds_read_b64 v[50:51], v9 offset:8448
    s_waitcnt lgkmcnt(6)
    v_mfma_f32_32x32x16_bf16 v[64:79], v[52:55], v[116:119], v[64:79]
    ds_read_b64 v[52:53], v9 offset:9216
    ds_read_b64 v[54:55], v9 offset:9472
    s_waitcnt lgkmcnt(6)
    v_mfma_f32_32x32x16_bf16 v[64:79], v[56:59], v[120:123], v[64:79]
    ds_read_b64 v[56:57], v9 offset:10240
    ds_read_b64 v[58:59], v9 offset:10496
    s_waitcnt lgkmcnt(6)
    v_mfma_f32_32x32x16_bf16 v[64:79], v[60:63], v[124:127], v[64:79]
    ds_read_b64 v[60:61], v9 offset:11264
    ds_read_b64 v[62:63], v9 offset:11520
    s_waitcnt lgkmcnt(6)
    v_mfma_f32_32x32x16_bf16 v[64:79], v[48:51], v[128:131], v[64:79]
    s_waitcnt vmcnt(16)
    s_barrier
    ds_read_b64 v[48:49], v9 offset:12288
    ds_read_b64 v[50:51], v9 offset:12544
    s_waitcnt lgkmcnt(6)
    v_mfma_f32_32x32x16_bf16 v[64:79], v[52:55], v[132:135], v[64:79]
    ds_read_b64 v[52:53], v9 offset:13312
    ds_read_b64 v[54:55], v9 offset:13568
    s_waitcnt lgkmcnt(6)
    v_mfma_f32_32x32x16_bf16 v[64:79], v[56:59], v[136:139], v[64:79]
    ds_read_b64 v[56:57], v9 offset:14336
    ds_read_b64 v[58:59], v9 offset:14592
    s_waitcnt lgkmcnt(6)
    v_mfma_f32_32x32x16_bf16 v[64:79], v[60:63], v[140:143], v[64:79]
    ds_read_b64 v[60:61], v9 offset:15360
    ds_read_b64 v[62:63], v9 offset:15616
    s_waitcnt lgkmcnt(6)
    v_mfma_f32_32x32x16_bf16 v[64:79], v[48:51], v[144:147], v[64:79]
    ds_read_b64 v[48:49], v9 offset:16384
    ds_read_b64 v[50:51], v9 offset:16640
    s_waitcnt lgkmcnt(6)
    v_mfma_f32_32x32x16_bf16 v[64:79], v[52:55], v[148:151], v[64:79]
    ds_read_b64 v[52:53], v9 offset:17408
    ds_read_b64 v[54:55], v9 offset:17664
    s_waitcnt lgkmcnt(6)
    v_mfma_f32_32x32x16_bf16 v[64:79], v[56:59], v[152:155], v[64:79]
    ds_read_b64 v[56:57], v9 offset:18432
    ds_read_b64 v[58:59], v9 offset:18688
    s_waitcnt lgkmcnt(6)
    v_mfma_f32_32x32x16_bf16 v[64:79], v[60:63], v[156:159], v[64:79]
    ds_read_b64 v[60:61], v9 offset:19456
    ds_read_b64 v[62:63], v9 offset:19712
    s_waitcnt lgkmcnt(6)
    v_mfma_f32_32x32x16_bf16 v[64:79], v[48:51], v[160:163], v[64:79]
    ds_read_b64 v[48:49], v9 offset:20480
    ds_read_b64 v[50:51], v9 offset:20736
    s_waitcnt lgkmcnt(6)
    v_mfma_f32_32x32x16_bf16 v[64:79], v[52:55], v[164:167], v[64:79]
    ds_read_b64 v[52:53], v9 offset:21504
    ds_read_b64 v[54:55], v9 offset:21760
    s_waitcnt lgkmcnt(6)
    v_mfma_f32_32x32x16_bf16 v[64:79], v[56:59], v[168:171], v[64:79]
    ds_read_b64 v[56:57], v9 offset:22528
    ds_read_b64 v[58:59], v9 offset:22784
    s_waitcnt lgkmcnt(6)
    v_mfma_f32_32x32x16_bf16 v[64:79], v[60:63], v[172:175], v[64:79]
    ds_read_b64 v[60:61], v9 offset:23552
    ds_read_b64 v[62:63], v9 offset:23808
    s_waitcnt lgkmcnt(6)
    v_mfma_f32_32x32x16_bf16 v[64:79], v[48:51], v[176:179], v[64:79]
    ds_read_b64 v[48:49], v9 offset:24576
    ds_read_b64 v[50:51], v9 offset:24832
    s_waitcnt lgkmcnt(6)
    v_mfma_f32_32x32x16_bf16 v[64:79], v[52:55], v[180:183], v[64:79]
    ds_read_b64 v[52:53], v9 offset:25600
    ds_read_b64 v[54:55], v9 offset:25856
    s_waitcnt lgkmcnt(6)
    v_mfma_f32_32x32x16_bf16 v[64:79], v[56:59], v[184:187], v[64:79]
    ds_read_b64 v[56:57], v9 offset:26624
    ds_read_b64 v[58:59], v9 offset:26880
    s_waitcnt lgkmcnt(6)
    v_mfma_f32_32x32x16_bf16 v[64:79], v[60:63], v[188:191], v[64:79]
    s_waitcnt vmcnt(0)
    s_barrier
    ds_read_b64 v[60:61], v9 offset:27648
    ds_read_b64 v[62:63], v9 offset:27904
    s_waitcnt lgkmcnt(6)
    v_mfma_f32_32x32x16_bf16 v[64:79], v[48:51], v[192:195], v[64:79]
    ds_read_b64 v[48:49], v9 offset:28672
    ds_read_b64 v[50:51], v9 offset:28928
    s_waitcnt lgkmcnt(6)
    v_mfma_f32_32x32x16_bf16 v[64:79], v[52:55], v[196:199], v[64:79]
    ds_read_b64 v[52:53], v9 offset:29696
    ds_read_b64 v[54:55], v9 offset:29952
    s_waitcnt lgkmcnt(6)
    v_mfma_f32_32x32x16_bf16 v[64:79], v[56:59], v[200:203], v[64:79]
    ds_read_b64 v[56:57], v9 offset:30720
    ds_read_b64 v[58:59], v9 offset:30976
    s_waitcnt lgkmcnt(6)
    v_mfma_f32_32x32x16_bf16 v[64:79], v[60:63], v[204:207], v[64:79]
    ds_read_b64 v[60:61], v9 offset:31744
    ds_read_b64 v[62:63], v9 offset:32000
    s_waitcnt lgkmcnt(6)
    v_mfma_f32_32x32x16_bf16 v[64:79], v[48:51], v[208:211], v[64:79]
    ds_read_b64 v[48:49], v9 offset:32768
    ds_read_b64 v[50:51], v9 offset:33024
    s_waitcnt lgkmcnt(6)
    v_mfma_f32_32x32x16_bf16 v[64:79], v[52:55], v[212:215], v[64:79]
    ds_read_b64 v[52:53], v9 offset:33792
    ds_read_b64 v[54:55], v9 offset:34048
    s_waitcnt lgkmcnt(6)
    v_mfma_f32_32x32x16_bf16 v[64:79], v[56:59], v[216:219], v[64:79]
    ds_read_b64 v[56:57], v9 offset:34816
    ds_read_b64 v[58:59], v9 offset:35072
    s_waitcnt lgkmcnt(6)
    v_mfma_f32_32x32x16_bf16 v[64:79], v[60:63], v[220:223], v[64:79]
    ds_read_b64 v[60:61], v9 offset:35840
    ds_read_b64 v[62:63], v9 offset:36096
    s_waitcnt lgkmcnt(6)
    v_mfma_f32_32x32x16_bf16 v[64:79], v[48:51], v[224:227], v[64:79]
    ds_read_b64 v[48:49], v9 offset:36864
    ds_read_b64 v[50:51], v9 offset:37120
    s_waitcnt lgkmcnt(6)
    v_mfma_f32_32x32x16_bf16 v[64:79], v[52:55], v[228:231], v[64:79]
    ds_read_b64 v[52:53], v9 offset:37888
    ds_read_b64 v[54:55], v9 offset:38144
    s_waitcnt lgkmcnt(6)
    v_mfma_f32_32x32x16_bf16 v[64:79], v[56:59], v[232:235], v[64:79]
    ds_read_b64 v[56:57], v9 offset:38912
    ds_read_b64 v[58:59], v9 offset:39168
    s_waitcnt lgkmcnt(6)
    v_mfma_f32_32x32x16_bf16 v[64:79], v[60:63], v[236:239], v[64:79]
    ds_read_b64 v[60:61], v9 offset:39936
    ds_read_b64 v[62:63], v9 offset:40192
    s_waitcnt lgkmcnt(6)
    v_mfma_f32_32x32x16_bf16 v[64:79], v[48:51], v[240:243], v[64:79]
    ds_read_b64 v[48:49], v9 offset:40960
    ds_read_b64 v[50:51], v9 offset:41216
    s_waitcnt lgkmcnt(6)
    v_mfma_f32_32x32x16_bf16 v[64:79], v[52:55], v[244:247], v[64:79]
    ds_read_b64 v[52:53], v9 offset:41984
    ds_read_b64 v[54:55], v9 offset:42240
    s_waitcnt lgkmcnt(6)
    v_mfma_f32_32x32x16_bf16 v[64:79], v[56:59], v[248:251], v[64:79]
    ds_read_b64 v[56:57], v9 offset:43008
    ds_read_b64 v[58:59], v9 offset:43264
    s_waitcnt lgkmcnt(6)
    v_mfma_f32_32x32x16_bf16 v[64:79], v[60:63], v[252:255], v[64:79]
    s_waitcnt lgkmcnt(4)
    v_mfma_f32_32x32x16_bf16 v[64:79], v[48:51], v[84:87], v[64:79]
    s_waitcnt lgkmcnt(2)
    v_mfma_f32_32x32x16_bf16 v[64:79], v[52:55], v[88:91], v[64:79]
    s_waitcnt lgkmcnt(0)
    v_mfma_f32_32x32x16_bf16 v[64:79], v[56:59], v[92:95], v[64:79]
    ds_read_b128 v[16:19], v8 offset:0
    ds_read_b128 v[48:51], v8 offset:8192
    ds_read_b128 v[20:23], v8 offset:1024
    ds_read_b128 v[52:55], v8 offset:9216
    ds_read_b128 v[24:27], v8 offset:2048
    ds_read_b128 v[56:59], v8 offset:10240
    ds_read_b128 v[28:31], v8 offset:3072
    ds_read_b128 v[60:63], v8 offset:11264
    s_waitcnt lgkmcnt(6)
    v_fma_f32 v16, s56, v48, v16
    v_fma_f32 v17, s56, v49, v17
    v_fma_f32 v18, s56, v50, v18
    v_fma_f32 v19, s56, v51, v19
    s_waitcnt lgkmcnt(4)
    v_fma_f32 v20, s56, v52, v20
    v_fma_f32 v21, s56, v53, v21
    v_fma_f32 v22, s56, v54, v22
    v_fma_f32 v23, s56, v55, v23
    s_waitcnt lgkmcnt(2)
    v_fma_f32 v24, s56, v56, v24
    v_fma_f32 v25, s56, v57, v25
    v_fma_f32 v26, s56, v58, v26
    v_fma_f32 v27, s56, v59, v27
    s_waitcnt lgkmcnt(0)
    v_fma_f32 v28, s56, v60, v28
    v_fma_f32 v29, s56, v61, v29
    v_fma_f32 v30, s56, v62, v30
    v_fma_f32 v31, s56, v63, v31
    v_mul_f32 v96, 0xbfb8aa3b, v64
    v_mul_f32 v97, 0xbfb8aa3b, v65
    v_mul_f32 v98, 0xbfb8aa3b, v66
    v_mul_f32 v99, 0xbfb8aa3b, v67
    v_exp_f32 v96, v96
    v_exp_f32 v97, v97
    v_exp_f32 v98, v98
    v_exp_f32 v99, v99
    v_mul_f32 v16, v16, v64
    v_mul_f32 v17, v17, v65
    v_mul_f32 v18, v18, v66
    v_mul_f32 v19, v19, v67
    v_add_f32 v96, 1.0, v96
    v_add_f32 v97, 1.0, v97
    v_add_f32 v98, 1.0, v98
    v_add_f32 v99, 1.0, v99
    v_rcp_f32 v96, v96
    v_rcp_f32 v97, v97
    v_rcp_f32 v98, v98
    v_rcp_f32 v99, v99
    s_nop 0
    v_fma_f32 v32, v16, v96, v32
    v_fma_f32 v33, v17, v97, v33
    v_fma_f32 v34, v18, v98, v34
    v_fma_f32 v35, v19, v99, v35
    v_cvt_pk_bf16_f32 v96, v32, v33
    s_add_u32 s3, s55, 0
    buffer_store_short v96, v7, s[40:43], s3 offen
    s_add_u32 s3, s55, 65536
    buffer_store_short_d16_hi v96, v7, s[40:43], s3 offen
    v_cvt_pk_bf16_f32 v98, v34, v35
    s_add_u32 s3, s55, 131072
    buffer_store_short v98, v7, s[40:43], s3 offen
    s_add_u32 s3, s55, 196608
    buffer_store_short_d16_hi v98, v7, s[40:43], s3 offen
    v_mul_f32 v100, 0xbfb8aa3b, v68
    v_mul_f32 v101, 0xbfb8aa3b, v69
    v_mul_f32 v102, 0xbfb8aa3b, v70
    v_mul_f32 v103, 0xbfb8aa3b, v71
    v_exp_f32 v100, v100
    v_exp_f32 v101, v101
    v_exp_f32 v102, v102
    v_exp_f32 v103, v103
    v_mul_f32 v20, v20, v68
    v_mul_f32 v21, v21, v69
    v_mul_f32 v22, v22, v70
    v_mul_f32 v23, v23, v71
    v_add_f32 v100, 1.0, v100
    v_add_f32 v101, 1.0, v101
    v_add_f32 v102, 1.0, v102
    v_add_f32 v103, 1.0, v103
    v_rcp_f32 v100, v100
    v_rcp_f32 v101, v101
    v_rcp_f32 v102, v102
    v_rcp_f32 v103, v103
    s_nop 0
    v_fma_f32 v36, v20, v100, v36
    v_fma_f32 v37, v21, v101, v37
    v_fma_f32 v38, v22, v102, v38
    v_fma_f32 v39, v23, v103, v39
    v_cvt_pk_bf16_f32 v100, v36, v37
    s_add_u32 s3, s55, 524288
    buffer_store_short v100, v7, s[40:43], s3 offen
    s_add_u32 s3, s55, 589824
    buffer_store_short_d16_hi v100, v7, s[40:43], s3 offen
    v_cvt_pk_bf16_f32 v102, v38, v39
    s_add_u32 s3, s55, 655360
    buffer_store_short v102, v7, s[40:43], s3 offen
    s_add_u32 s3, s55, 720896
    buffer_store_short_d16_hi v102, v7, s[40:43], s3 offen
    v_mul_f32 v104, 0xbfb8aa3b, v72
    v_mul_f32 v105, 0xbfb8aa3b, v73
    v_mul_f32 v106, 0xbfb8aa3b, v74
    v_mul_f32 v107, 0xbfb8aa3b, v75
    v_exp_f32 v104, v104
    v_exp_f32 v105, v105
    v_exp_f32 v106, v106
    v_exp_f32 v107, v107
    v_mul_f32 v24, v24, v72
    v_mul_f32 v25, v25, v73
    v_mul_f32 v26, v26, v74
    v_mul_f32 v27, v27, v75
    v_add_f32 v104, 1.0, v104
    v_add_f32 v105, 1.0, v105
    v_add_f32 v106, 1.0, v106
    v_add_f32 v107, 1.0, v107
    v_rcp_f32 v104, v104
    v_rcp_f32 v105, v105
    v_rcp_f32 v106, v106
    v_rcp_f32 v107, v107
    s_nop 0
    v_fma_f32 v40, v24, v104, v40
    v_fma_f32 v41, v25, v105, v41
    v_fma_f32 v42, v26, v106, v42
    v_fma_f32 v43, v27, v107, v43
    v_cvt_pk_bf16_f32 v104, v40, v41
    s_add_u32 s3, s55, 1048576
    buffer_store_short v104, v7, s[40:43], s3 offen
    s_add_u32 s3, s55, 1114112
    buffer_store_short_d16_hi v104, v7, s[40:43], s3 offen
    v_cvt_pk_bf16_f32 v106, v42, v43
    s_add_u32 s3, s55, 1179648
    buffer_store_short v106, v7, s[40:43], s3 offen
    s_add_u32 s3, s55, 1245184
    buffer_store_short_d16_hi v106, v7, s[40:43], s3 offen
    v_mul_f32 v108, 0xbfb8aa3b, v76
    v_mul_f32 v109, 0xbfb8aa3b, v77
    v_mul_f32 v110, 0xbfb8aa3b, v78
    v_mul_f32 v111, 0xbfb8aa3b, v79
    v_exp_f32 v108, v108
    v_exp_f32 v109, v109
    v_exp_f32 v110, v110
    v_exp_f32 v111, v111
    v_mul_f32 v28, v28, v76
    v_mul_f32 v29, v29, v77
    v_mul_f32 v30, v30, v78
    v_mul_f32 v31, v31, v79
    v_add_f32 v108, 1.0, v108
    v_add_f32 v109, 1.0, v109
    v_add_f32 v110, 1.0, v110
    v_add_f32 v111, 1.0, v111
    v_rcp_f32 v108, v108
    v_rcp_f32 v109, v109
    v_rcp_f32 v110, v110
    v_rcp_f32 v111, v111
    s_nop 0
    v_fma_f32 v44, v28, v108, v44
    v_fma_f32 v45, v29, v109, v45
    v_fma_f32 v46, v30, v110, v46
    v_fma_f32 v47, v31, v111, v47
    v_cvt_pk_bf16_f32 v108, v44, v45
    s_add_u32 s3, s55, 1572864
    buffer_store_short v108, v7, s[40:43], s3 offen
    s_add_u32 s3, s55, 1638400
    buffer_store_short_d16_hi v108, v7, s[40:43], s3 offen
    v_cvt_pk_bf16_f32 v110, v46, v47
    s_add_u32 s3, s55, 1703936
    buffer_store_short v110, v7, s[40:43], s3 offen
    s_add_u32 s3, s55, 1769472
    buffer_store_short_d16_hi v110, v7, s[40:43], s3 offen
    s_branch L_fin
L_soft_p3_dft:
    v_lshrrev_b32 v4, 3, v1
    v_lshlrev_b32 v4, 8, v4
    v_and_b32 v5, 7, v1
    v_lshl_add_u32 v12, v5, 4, v4
    s_and_b32 s3, s2, 7
    s_lshl_b32 s3, s3, 11
    s_add_u32 s62, s3, 14712832
    buffer_load_dwordx2 v[2:3], v12, s[16:19], s62 offen
    buffer_load_dwordx2 v[4:5], v12, s[16:19], s62 offen offset:8
    s_waitcnt vmcnt(17)
    v_mfma_f32_16x16x32_bf16 v[48:51], v[96:99], v[128:131], 0
    v_lshlrev_b32 v20, 16, v14
    v_mfma_f32_16x16x32_bf16 v[52:55], v[96:99], v[160:163], 0
    v_mfma_f32_16x16x32_bf16 v[56:59], v[96:99], v[192:195], 0
    v_and_b32 v21, 0xffff0000, v14
    ds_write_b128 v9, v[32:35] offset:0
    v_mfma_f32_16x16x32_bf16 v[60:63], v[96:99], v[224:227], 0
    v_permlane32_swap_b32 v16, v18
    v_mfma_f32_16x16x32_bf16 v[48:51], v[100:103], v[132:135], v[48:51]
    v_mfma_f32_16x16x32_bf16 v[52:55], v[100:103], v[164:167], v[52:55]
    v_permlane32_swap_b32 v17, v19
    ds_write_b128 v9, v[36:39] offset:1024
    v_mfma_f32_16x16x32_bf16 v[56:59], v[100:103], v[196:199], v[56:59]
    v_add_f32 v16, v16, v18
    v_mfma_f32_16x16x32_bf16 v[60:63], v[100:103], v[228:231], v[60:63]
    ds_write_b128 v9, v[40:43] offset:2048
    s_waitcnt vmcnt(15)
    v_mfma_f32_16x16x32_bf16 v[48:51], v[104:107], v[136:139], v[48:51]
    v_add_f32 v17, v17, v19
    v_mfma_f32_16x16x32_bf16 v[52:55], v[104:107], v[168:171], v[52:55]
    v_add_f32 v16, v16, v15
    v_mfma_f32_16x16x32_bf16 v[56:59], v[104:107], v[200:203], v[56:59]
    v_add_f32 v17, v17, v15
    ds_write_b128 v9, v[44:47] offset:3072
    v_mfma_f32_16x16x32_bf16 v[60:63], v[104:107], v[232:235], v[60:63]
    v_mul_f32 v16, v16, v20
    v_mfma_f32_16x16x32_bf16 v[48:51], v[108:111], v[140:143], v[48:51]
    v_mfma_f32_16x16x32_bf16 v[52:55], v[108:111], v[172:175], v[52:55]
    v_mul_f32 v17, v17, v21
    v_mfma_f32_16x16x32_bf16 v[56:59], v[108:111], v[204:207], v[56:59]
    v_cvt_pk_bf16_f32 v6, v16, v17
    v_mfma_f32_16x16x32_bf16 v[60:63], v[108:111], v[236:239], v[60:63]
    s_lshl_b32 s4, s57, 5
    s_and_b32 s4, s4, 0xff
    s_waitcnt vmcnt(13)
    v_mfma_f32_16x16x32_bf16 v[48:51], v[112:115], v[144:147], v[48:51]
    s_waitcnt lgkmcnt(0)
    s_barrier
    v_xor_b32 v14, s4, v11
    ds_read_b128 v[16:19], v8 offset:0
    v_mfma_f32_16x16x32_bf16 v[52:55], v[112:115], v[176:179], v[52:55]
    ds_read_b128 v[20:23], v8 offset:4096
    ds_read_b128 v[24:27], v8 offset:8192
    v_mfma_f32_16x16x32_bf16 v[56:59], v[112:115], v[208:211], v[56:59]
    ds_read_b128 v[28:31], v8 offset:12288
    ds_read_b32 v14, v14
    v_mfma_f32_16x16x32_bf16 v[60:63], v[112:115], v[240:243], v[60:63]
    v_mfma_f32_16x16x32_bf16 v[48:51], v[116:119], v[148:151], v[48:51]
    v_mfma_f32_16x16x32_bf16 v[52:55], v[116:119], v[180:183], v[52:55]
    v_mfma_f32_16x16x32_bf16 v[56:59], v[116:119], v[212:215], v[56:59]
    v_mfma_f32_16x16x32_bf16 v[60:63], v[116:119], v[244:247], v[60:63]
    s_waitcnt lgkmcnt(0)
    s_waitcnt vmcnt(11)
    v_mfma_f32_16x16x32_bf16 v[48:51], v[120:123], v[152:155], v[48:51]
    v_add_f32 v16, v16, v20
    v_mfma_f32_16x16x32_bf16 v[52:55], v[120:123], v[184:187], v[52:55]
    v_add_f32 v24, v24, v28
    v_add_f32 v17, v17, v21
    v_mfma_f32_16x16x32_bf16 v[56:59], v[120:123], v[216:219], v[56:59]
    v_add_f32 v25, v25, v29
    v_mfma_f32_16x16x32_bf16 v[60:63], v[120:123], v[248:251], v[60:63]
    v_add_f32 v18, v18, v22
    v_add_f32 v26, v26, v30
    v_mfma_f32_16x16x32_bf16 v[48:51], v[124:127], v[156:159], v[48:51]
    v_add_f32 v19, v19, v23
    v_mfma_f32_16x16x32_bf16 v[52:55], v[124:127], v[188:191], v[52:55]
    v_add_f32 v27, v27, v31
    v_add_f32 v16, v16, v24
    v_mfma_f32_16x16x32_bf16 v[56:59], v[124:127], v[220:223], v[56:59]
    v_add_f32 v17, v17, v25
    v_mfma_f32_16x16x32_bf16 v[60:63], v[124:127], v[252:255], v[60:63]
    v_add_f32 v18, v18, v26
    v_add_f32 v19, v19, v27
    s_waitcnt vmcnt(0)
    v_xor_b32 v2, s45, v2
    v_xor_b32 v3, s45, v3
    v_xor_b32 v4, s45, v4
    v_xor_b32 v5, s45, v5
    v_or3_b32 v4, v4, v5, v2
    v_or_b32 v4, v4, v3
    v_cmp_ne_u32 vcc, 0, v4
    s_nop 3
    s_cbranch_vccz L_soft_p3_u
    s_mov_b32 s61, 0
L_soft_poll3:
    buffer_load_dwordx4 v[96:99], v12, s[16:19], s62 offen sc1
    s_waitcnt vmcnt(0)
    v_xor_b32 v2, s45, v96
    v_xor_b32 v97, s45, v97
    v_or_b32 v2, v2, v97
    v_xor_b32 v98, s45, v98
    v_or_b32 v2, v2, v98
    v_xor_b32 v99, s45, v99
    v_or_b32 v2, v2, v99
    v_cmp_ne_u32 vcc, 0, v2
    s_add_u32 s61, s61, 1
    s_cmp_gt_u32 s61, 20000
    s_nop 1
    s_cbranch_scc1 L_soft_pollx3
    s_cbranch_vccnz L_soft_poll3
L_soft_pollx3:
L_soft_p3_u:
    s_lshl_b32 s3, s2, 3
    s_add_u32 s3, s3, s44
    s_cmp_lg_u32 s3, 4
    s_cbranch_scc1 L_soft_p3_e
    s_mov_b32 s3, 14680064
    v_mul_u32_u24 v2, 0, v1
    v_cmp_gt_u32 vcc, 1, v1
    v_mov_b32 v3, 0x40000000
    s_nop 0
    v_cndmask_b32 v2, v3, v2, vcc
    v_mov_b32 v3, s45
    buffer_store_dword v3, v2, s[16:19], s3 offen sc1
L_soft_p3_e:
    s_and_b32 s50, s44, 3
    s_lshl_b32 s3, s46, 15
    s_lshl_b32 s52, s50, 13
    s_add_u32 s51, s3, s52
    s_add_u32 s51, s51, 8388608
    s_and_b32 s3, s50, 1
    s_lshl_b32 s3, s3, 3
    v_xor_b32 v4, s3, v1
    v_lshlrev_b32 v4, 4, v4
    s_waitcnt vmcnt(9)
    v_mfma_f32_16x16x32_bf16 v[32:35], v[64:67], v[128:131], 0
    v_lshlrev_b32 v20, 16, v14
    v_mfma_f32_16x16x32_bf16 v[36:39], v[64:67], v[160:163], 0
    v_mfma_f32_16x16x32_bf16 v[40:43], v[64:67], v[192:195], 0
    v_and_b32 v21, 0xffff0000, v14
    v_permlane32_swap_b32 v16, v18
    ds_write_b128 v9, v[48:51] offset:32768
    v_xor_b32 v5, 0, v4
    s_add_u32 m0, s52, 81920
    s_add_u32 s3, s51, 0
    buffer_load_dwordx4 v5, s[16:19], s3 offen lds
    v_mfma_f32_16x16x32_bf16 v[44:47], v[64:67], v[224:227], 0
    v_permlane32_swap_b32 v17, v19
    v_mfma_f32_16x16x32_bf16 v[32:35], v[68:71], v[132:135], v[32:35]
    v_xor_b32 v5, 16, v4
    s_add_u32 m0, s52, 82944
    s_add_u32 s3, s51, 1024
    buffer_load_dwordx4 v5, s[16:19], s3 offen lds
    v_mfma_f32_16x16x32_bf16 v[36:39], v[68:71], v[164:167], v[36:39]
    v_add_f32 v16, v16, v18
    v_add_f32 v17, v17, v19
    ds_write_b128 v9, v[52:55] offset:33792
    v_mfma_f32_16x16x32_bf16 v[40:43], v[68:71], v[196:199], v[40:43]
    v_add_f32 v16, v16, v15
    v_xor_b32 v5, 32, v4
    s_add_u32 m0, s52, 83968
    s_add_u32 s3, s51, 2048
    buffer_load_dwordx4 v5, s[16:19], s3 offen lds
    v_mfma_f32_16x16x32_bf16 v[44:47], v[68:71], v[228:231], v[44:47]
    ds_write_b128 v9, v[56:59] offset:34816
    s_waitcnt vmcnt(9)
    v_mfma_f32_16x16x32_bf16 v[32:35], v[72:75], v[136:139], v[32:35]
    v_add_f32 v17, v17, v15
    v_mul_f32 v16, v16, v20
    v_xor_b32 v5, 48, v4
    s_add_u32 m0, s52, 84992
    s_add_u32 s3, s51, 3072
    buffer_load_dwordx4 v5, s[16:19], s3 offen lds
    v_mfma_f32_16x16x32_bf16 v[36:39], v[72:75], v[168:171], v[36:39]
    v_mul_f32 v17, v17, v21
    v_mfma_f32_16x16x32_bf16 v[40:43], v[72:75], v[200:203], v[40:43]
    v_cvt_pk_bf16_f32 v7, v16, v17
    v_mov_b32 v18, s56
    ds_write_b128 v9, v[60:63] offset:35840
    v_mfma_f32_16x16x32_bf16 v[44:47], v[72:75], v[232:235], v[44:47]
    v_mov_b32 v19, s57
    v_xor_b32 v5, 64, v4
    s_add_u32 m0, s52, 86016
    s_add_u32 s3, s51, 4096
    buffer_load_dwordx4 v5, s[16:19], s3 offen lds
    v_mfma_f32_16x16x32_bf16 v[32:35], v[76:79], v[140:143], v[32:35]
    v_mfma_f32_16x16x32_bf16 v[36:39], v[76:79], v[172:175], v[36:39]
    v_cndmask_b32 v18, v18, v19, s[84:85]
    v_lshl_add_u32 v18, v18, 10, v13
    v_xor_b32 v5, 80, v4
    s_add_u32 m0, s52, 87040
    s_add_u32 s3, s51, 5120
    buffer_load_dwordx4 v5, s[16:19], s3 offen lds
    v_mfma_f32_16x16x32_bf16 v[40:43], v[76:79], v[204:207], v[40:43]
    v_permlane32_swap_b32 v6, v7
    buffer_store_dwordx2 v[6:7], v18, s[16:19], s78 offen sc1
    v_mfma_f32_16x16x32_bf16 v[44:47], v[76:79], v[236:239], v[44:47]
    s_lshl_b32 s4, s58, 5
    s_and_b32 s4, s4, 0xff
    v_xor_b32 v5, 96, v4
    s_add_u32 m0, s52, 88064
    s_add_u32 s3, s51, 6144
    buffer_load_dwordx4 v5, s[16:19], s3 offen lds
    s_waitcnt vmcnt(12)
    v_mfma_f32_16x16x32_bf16 v[32:35], v[80:83], v[144:147], v[32:35]
    s_waitcnt lgkmcnt(0)
    s_barrier
    v_xor_b32 v14, s4, v11
    ds_read_b128 v[16:19], v8 offset:32768
    v_mfma_f32_16x16x32_bf16 v[36:39], v[80:83], v[176:179], v[36:39]
    ds_read_b128 v[20:23], v8 offset:36864
    ds_read_b128 v[24:27], v8 offset:40960
    v_xor_b32 v5, 112, v4
    s_add_u32 m0, s52, 89088
    s_add_u32 s3, s51, 7168
    buffer_load_dwordx4 v5, s[16:19], s3 offen lds
    v_mfma_f32_16x16x32_bf16 v[40:43], v[80:83], v[208:211], v[40:43]
    ds_read_b128 v[28:31], v8 offset:45056
    ds_read_b32 v14, v14
    v_mfma_f32_16x16x32_bf16 v[44:47], v[80:83], v[240:243], v[44:47]
    v_mfma_f32_16x16x32_bf16 v[32:35], v[84:87], v[148:151], v[32:35]
    v_mfma_f32_16x16x32_bf16 v[36:39], v[84:87], v[180:183], v[36:39]
    v_mfma_f32_16x16x32_bf16 v[40:43], v[84:87], v[212:215], v[40:43]
    s_waitcnt lgkmcnt(0)
    v_add_f32 v16, v16, v20
    v_mfma_f32_16x16x32_bf16 v[44:47], v[84:87], v[244:247], v[44:47]
    v_add_f32 v24, v24, v28
    v_add_f32 v17, v17, v21
    s_waitcnt vmcnt(11)
    v_mfma_f32_16x16x32_bf16 v[32:35], v[88:91], v[152:155], v[32:35]
    v_add_f32 v25, v25, v29
    v_add_f32 v18, v18, v22
    v_add_f32 v26, v26, v30
    v_mfma_f32_16x16x32_bf16 v[36:39], v[88:91], v[184:187], v[36:39]
    v_add_f32 v19, v19, v23
    v_add_f32 v27, v27, v31
    v_mfma_f32_16x16x32_bf16 v[40:43], v[88:91], v[216:219], v[40:43]
    v_add_f32 v16, v16, v24
    v_add_f32 v17, v17, v25
    v_add_f32 v18, v18, v26
    v_mfma_f32_16x16x32_bf16 v[44:47], v[88:91], v[248:251], v[44:47]
    v_add_f32 v19, v19, v27
    v_lshlrev_b32 v20, 16, v14
    v_mfma_f32_16x16x32_bf16 v[32:35], v[92:95], v[156:159], v[32:35]
    v_and_b32 v21, 0xffff0000, v14
    v_permlane32_swap_b32 v16, v18
    v_mfma_f32_16x16x32_bf16 v[36:39], v[92:95], v[188:191], v[36:39]
    v_permlane32_swap_b32 v17, v19
    v_add_f32 v16, v16, v18
    v_add_f32 v17, v17, v19
    v_mfma_f32_16x16x32_bf16 v[40:43], v[92:95], v[220:223], v[40:43]
    v_add_f32 v16, v16, v15
    v_add_f32 v17, v17, v15
    v_mfma_f32_16x16x32_bf16 v[44:47], v[92:95], v[252:255], v[44:47]
    v_mul_f32 v16, v16, v20
    v_mul_f32 v17, v17, v21
    v_cvt_pk_bf16_f32 v6, v16, v17
    ds_write_b128 v9, v[32:35] offset:0
    ds_write_b128 v9, v[36:39] offset:1024
    ds_write_b128 v9, v[40:43] offset:2048
    s_nop 1
    ds_write_b128 v9, v[44:47] offset:3072
    s_waitcnt lgkmcnt(0)
    s_barrier
    s_lshl_b32 s4, s59, 5
    s_and_b32 s4, s4, 0xff
    v_xor_b32 v14, s4, v11
    ds_read_b128 v[16:19], v8 offset:0
    ds_read_b128 v[20:23], v8 offset:4096
    ds_read_b128 v[24:27], v8 offset:8192
    ds_read_b128 v[28:31], v8 offset:12288
    ds_read_b32 v14, v14
    s_waitcnt lgkmcnt(0)
    v_add_f32 v16, v16, v20
    v_add_f32 v24, v24, v28
    v_add_f32 v17, v17, v21
    v_add_f32 v25, v25, v29
    v_add_f32 v18, v18, v22
    v_add_f32 v26, v26, v30
    v_add_f32 v19, v19, v23
    v_add_f32 v27, v27, v31
    v_add_f32 v16, v16, v24
    v_add_f32 v17, v17, v25
    v_add_f32 v18, v18, v26
    v_add_f32 v19, v19, v27
    v_lshlrev_b32 v20, 16, v14
    v_and_b32 v21, 0xffff0000, v14
    v_permlane32_swap_b32 v16, v18
    v_permlane32_swap_b32 v17, v19
    v_add_f32 v16, v16, v18
    v_add_f32 v17, v17, v19
    v_add_f32 v16, v16, v15
    v_add_f32 v17, v17, v15
    v_mul_f32 v16, v16, v20
    v_mul_f32 v17, v17, v21
    v_cvt_pk_bf16_f32 v7, v16, v17
    v_mov_b32 v18, s58
    v_mov_b32 v19, s59
    v_cndmask_b32 v18, v18, v19, s[84:85]
    v_lshl_add_u32 v18, v18, 10, v13
    v_permlane32_swap_b32 v6, v7
    buffer_store_dwordx2 v[6:7], v18, s[16:19], s78 offen sc1
    v_and_b32 v10, 31, v1
    v_lshrrev_b32 v11, 5, v1
    v_and_b32 v5, 15, v10
    v_xor_b32 v5, v5, v11
    v_lshlrev_b32 v5, 4, v5
    v_lshl_add_u32 v176, v10, 10, v5
    v_add_u32 v176, 81920, v176
    v_xor_b32 v177, 32, v176
    v_xor_b32 v178, 64, v176
    v_xor_b32 v179, 96, v176
    v_xor_b32 v180, 128, v176
    v_xor_b32 v181, 160, v176
    v_xor_b32 v182, 192, v176
    v_xor_b32 v183, 224, v176
    s_lshl_b32 s3, s47, 7
    s_lshl_b32 s4, s48, 6
    s_add_u32 s3, s3, s4
    s_add_u32 s3, s3, 1
    v_lshl_add_u32 v14, v10, 1, s3
    v_lshlrev_b32 v5, 3, v11
    v_add_u32 v5, 1, v5
    v_mul_u32_u24 v5, v5, v14
    s_lshl_b32 s3, s49, 8
    v_subrev_u32 v5, s3, v5
    v_lshlrev_b32 v7, 4, v14
    v_and_b32 v8, 1023, v5
    v_sub_u32 v9, v5, v7
    v_cvt_f32_u32 v8, v8
    v_and_b32 v9, 1023, v9
    v_mul_f32 v8, 0x3a800000, v8
    v_cvt_f32_u32 v9, v9
    v_cos_f32 v96, v8
    v_mul_f32 v9, 0x3a800000, v9
    v_add_u32 v5, v5, v14
    v_cos_f32 v104, v9
    v_and_b32 v8, 1023, v5
    v_sub_u32 v9, v5, v7
    v_cvt_f32_u32 v8, v8
    v_and_b32 v9, 1023, v9
    v_mul_f32 v8, 0x3a800000, v8
    v_cvt_f32_u32 v9, v9
    v_cos_f32 v97, v8
    v_mul_f32 v9, 0x3a800000, v9
    v_add_u32 v5, v5, v14
    v_cos_f32 v105, v9
    v_and_b32 v8, 1023, v5
    v_sub_u32 v9, v5, v7
    v_cvt_f32_u32 v8, v8
    v_and_b32 v9, 1023, v9
    v_mul_f32 v8, 0x3a800000, v8
    v_cvt_f32_u32 v9, v9
    v_cos_f32 v98, v8
    v_mul_f32 v9, 0x3a800000, v9
    v_add_u32 v5, v5, v14
    v_cos_f32 v106, v9
    v_and_b32 v8, 1023, v5
    v_sub_u32 v9, v5, v7
    v_cvt_f32_u32 v8, v8
    v_and_b32 v9, 1023, v9
    v_mul_f32 v8, 0x3a800000, v8
    v_cvt_f32_u32 v9, v9
    v_cos_f32 v99, v8
    v_mul_f32 v9, 0x3a800000, v9
    v_add_u32 v5, v5, v14
    v_cos_f32 v107, v9
    v_and_b32 v8, 1023, v5
    v_sub_u32 v9, v5, v7
    v_cvt_f32_u32 v8, v8
    v_and_b32 v9, 1023, v9
    v_mul_f32 v8, 0x3a800000, v8
    v_cvt_f32_u32 v9, v9
    v_cos_f32 v100, v8
    v_mul_f32 v9, 0x3a800000, v9
    v_add_u32 v5, v5, v14
    v_cos_f32 v108, v9
    v_and_b32 v8, 1023, v5
    v_sub_u32 v9, v5, v7
    v_cvt_f32_u32 v8, v8
    v_and_b32 v9, 1023, v9
    v_mul_f32 v8, 0x3a800000, v8
    v_cvt_f32_u32 v9, v9
    v_cos_f32 v101, v8
    v_mul_f32 v9, 0x3a800000, v9
    v_add_u32 v5, v5, v14
    v_cos_f32 v109, v9
    v_and_b32 v8, 1023, v5
    v_sub_u32 v9, v5, v7
    v_cvt_f32_u32 v8, v8
    v_and_b32 v9, 1023, v9
    v_mul_f32 v8, 0x3a800000, v8
    v_cvt_f32_u32 v9, v9
    v_cos_f32 v102, v8
    v_mul_f32 v9, 0x3a800000, v9
    v_add_u32 v5, v5, v14
    v_cos_f32 v110, v9
    v_and_b32 v8, 1023, v5
    v_sub_u32 v9, v5, v7
    v_cvt_f32_u32 v8, v8
    v_and_b32 v9, 1023, v9
    v_mul_f32 v8, 0x3a800000, v8
    v_cvt_f32_u32 v9, v9
    v_cos_f32 v103, v8
    v_mul_f32 v9, 0x3a800000, v9
    v_cos_f32 v111, v9
    v_and_b32 v8, 63, v14
    v_cvt_f32_u32 v8, v8
    v_mul_f32 v8, 0x3c800000, v8
    v_cos_f32 v15, v8
    v_lshlrev_b32 v6, 6, v10
    v_add_u32 v6, s46, v6
    v_lshlrev_b32 v5, 2, v11
    v_mul_u32_u24 v5, v5, v6
    s_lshl_b32 s3, s49, 9
    v_add_u32 v5, s3, v5
    v_add_f32 v15, v15, v15
    s_waitcnt vmcnt(0)
    s_barrier
    ds_read_b128 v[128:131], v176 offset:0
    ds_read_b128 v[132:135], v178 offset:0
    ds_read_b128 v[136:139], v177 offset:0
    ds_read_b128 v[140:143], v179 offset:0
    ds_read_b128 v[144:147], v180 offset:0
    ds_read_b128 v[148:151], v182 offset:0
    v_cvt_pk_bf16_f32 v112, v96, v97
    v_cvt_pk_bf16_f32 v113, v98, v99
    v_cvt_pk_bf16_f32 v114, v100, v101
    v_cvt_pk_bf16_f32 v115, v102, v103
    s_waitcnt lgkmcnt(4)
    s_nop 0
    v_mfma_f32_32x32x16_bf16 v[64:79], v[128:131], v[112:115], 0
    v_mad_u32_u24 v8, v6, 0, v5
    v_and_b32 v8, 2047, v8
    v_cvt_f32_u32 v8, v8
    v_fma_f32 v104, v15, v96, -v104
    v_fma_f32 v105, v15, v97, -v105
    v_fma_f32 v106, v15, v98, -v106
    v_fma_f32 v107, v15, v99, -v107
    v_mfma_f32_32x32x16_bf16 v[80:95], v[132:135], v[112:115], 0
    v_mul_f32 v8, 0x3a000000, v8
    v_cos_f32 v24, v8
    v_sin_f32 v26, v8
    v_mad_u32_u24 v8, v6, 1, v5
    v_fma_f32 v108, v15, v100, -v108
    v_fma_f32 v109, v15, v101, -v109
    v_fma_f32 v110, v15, v102, -v110
    v_fma_f32 v111, v15, v103, -v111
    ds_read_b128 v[152:155], v181 offset:0
    ds_read_b128 v[156:159], v183 offset:0
    v_cvt_pk_bf16_f32 v116, v104, v105
    v_cvt_pk_bf16_f32 v117, v106, v107
    v_cvt_pk_bf16_f32 v118, v108, v109
    v_cvt_pk_bf16_f32 v119, v110, v111
    s_waitcnt lgkmcnt(4)
    s_nop 0
    v_mfma_f32_32x32x16_bf16 v[64:79], v[136:139], v[116:119], v[64:79]
    v_and_b32 v8, 2047, v8
    v_cvt_f32_u32 v8, v8
    v_mul_f32 v8, 0x3a000000, v8
    v_fma_f32 v96, v15, v104, -v96
    v_fma_f32 v97, v15, v105, -v97
    v_fma_f32 v98, v15, v106, -v98
    v_fma_f32 v99, v15, v107, -v99
    v_mfma_f32_32x32x16_bf16 v[80:95], v[140:143], v[116:119], v[80:95]
    v_cos_f32 v25, v8
    v_sin_f32 v27, v8
    v_cvt_pk_bf16_f32 v160, v24, v25
    v_cvt_pk_bf16_f32 v168, -v26, -v27
    v_fma_f32 v100, v15, v108, -v100
    v_fma_f32 v101, v15, v109, -v101
    v_fma_f32 v102, v15, v110, -v102
    v_fma_f32 v103, v15, v111, -v103
    ds_read_b128 v[128:131], v176 offset:256
    ds_read_b128 v[132:135], v178 offset:256
    v_cvt_pk_bf16_f32 v112, v96, v97
    v_cvt_pk_bf16_f32 v113, v98, v99
    v_cvt_pk_bf16_f32 v114, v100, v101
    v_cvt_pk_bf16_f32 v115, v102, v103
    s_waitcnt lgkmcnt(4)
    s_nop 0
    v_mfma_f32_32x32x16_bf16 v[64:79], v[144:147], v[112:115], v[64:79]
    v_mad_u32_u24 v8, v6, 2, v5
    v_and_b32 v8, 2047, v8
    v_cvt_f32_u32 v8, v8
    v_fma_f32 v104, v15, v96, -v104
    v_fma_f32 v105, v15, v97, -v105
    v_fma_f32 v106, v15, v98, -v106
    v_fma_f32 v107, v15, v99, -v107
    v_mfma_f32_32x32x16_bf16 v[80:95], v[148:151], v[112:115], v[80:95]
    v_mul_f32 v8, 0x3a000000, v8
    v_cos_f32 v24, v8
    v_sin_f32 v26, v8
    v_mad_u32_u24 v8, v6, 3, v5
    v_fma_f32 v108, v15, v100, -v108
    v_fma_f32 v109, v15, v101, -v109
    v_fma_f32 v110, v15, v102, -v110
    v_fma_f32 v111, v15, v103, -v111
    ds_read_b128 v[136:139], v177 offset:256
    ds_read_b128 v[140:143], v179 offset:256
    v_cvt_pk_bf16_f32 v116, v104, v105
    v_cvt_pk_bf16_f32 v117, v106, v107
    v_cvt_pk_bf16_f32 v118, v108, v109
    v_cvt_pk_bf16_f32 v119, v110, v111
    s_waitcnt lgkmcnt(4)
    s_nop 0
    v_mfma_f32_32x32x16_bf16 v[64:79], v[152:155], v[116:119], v[64:79]
    v_and_b32 v8, 2047, v8
    v_cvt_f32_u32 v8, v8
    v_mul_f32 v8, 0x3a000000, v8
    v_fma_f32 v96, v15, v104, -v96
    v_fma_f32 v97, v15, v105, -v97
    v_fma_f32 v98, v15, v106, -v98
    v_fma_f32 v99, v15, v107, -v99
    v_mfma_f32_32x32x16_bf16 v[80:95], v[156:159], v[116:119], v[80:95]
    v_cos_f32 v25, v8
    v_sin_f32 v27, v8
    v_cvt_pk_bf16_f32 v161, v24, v25
    v_cvt_pk_bf16_f32 v169, -v26, -v27
    v_fma_f32 v100, v15, v108, -v100
    v_fma_f32 v101, v15, v109, -v101
    v_fma_f32 v102, v15, v110, -v102
    v_fma_f32 v103, v15, v111, -v103
    ds_read_b128 v[144:147], v180 offset:256
    ds_read_b128 v[148:151], v182 offset:256
    v_cvt_pk_bf16_f32 v112, v96, v97
    v_cvt_pk_bf16_f32 v113, v98, v99
    v_cvt_pk_bf16_f32 v114, v100, v101
    v_cvt_pk_bf16_f32 v115, v102, v103
    s_waitcnt lgkmcnt(4)
    s_nop 0
    v_mfma_f32_32x32x16_bf16 v[64:79], v[128:131], v[112:115], v[64:79]
    v_mad_u32_u24 v8, v6, 8, v5
    v_and_b32 v8, 2047, v8
    v_cvt_f32_u32 v8, v8
    v_fma_f32 v104, v15, v96, -v104
    v_fma_f32 v105, v15, v97, -v105
    v_fma_f32 v106, v15, v98, -v106
    v_fma_f32 v107, v15, v99, -v107
    v_mfma_f32_32x32x16_bf16 v[80:95], v[132:135], v[112:115], v[80:95]
    v_mul_f32 v8, 0x3a000000, v8
    v_cos_f32 v24, v8
    v_sin_f32 v26, v8
    v_mad_u32_u24 v8, v6, 9, v5
    v_fma_f32 v108, v15, v100, -v108
    v_fma_f32 v109, v15, v101, -v109
    v_fma_f32 v110, v15, v102, -v110
    v_fma_f32 v111, v15, v103, -v111
    ds_read_b128 v[152:155], v181 offset:256
    ds_read_b128 v[156:159], v183 offset:256
    v_cvt_pk_bf16_f32 v116, v104, v105
    v_cvt_pk_bf16_f32 v117, v106, v107
    v_cvt_pk_bf16_f32 v118, v108, v109
    v_cvt_pk_bf16_f32 v119, v110, v111
    s_waitcnt lgkmcnt(4)
    s_nop 0
    v_mfma_f32_32x32x16_bf16 v[64:79], v[136:139], v[116:119], v[64:79]
    v_and_b32 v8, 2047, v8
    v_cvt_f32_u32 v8, v8
    v_mul_f32 v8, 0x3a000000, v8
    v_fma_f32 v96, v15, v104, -v96
    v_fma_f32 v97, v15, v105, -v97
    v_fma_f32 v98, v15, v106, -v98
    v_fma_f32 v99, v15, v107, -v99
    v_mfma_f32_32x32x16_bf16 v[80:95], v[140:143], v[116:119], v[80:95]
    v_cos_f32 v25, v8
    v_sin_f32 v27, v8
    v_cvt_pk_bf16_f32 v162, v24, v25
    v_cvt_pk_bf16_f32 v170, -v26, -v27
    v_fma_f32 v100, v15, v108, -v100
    v_fma_f32 v101, v15, v109, -v101
    v_fma_f32 v102, v15, v110, -v102
    v_fma_f32 v103, v15, v111, -v103
    ds_read_b128 v[128:131], v176 offset:512
    ds_read_b128 v[132:135], v178 offset:512
    v_cvt_pk_bf16_f32 v112, v96, v97
    v_cvt_pk_bf16_f32 v113, v98, v99
    v_cvt_pk_bf16_f32 v114, v100, v101
    v_cvt_pk_bf16_f32 v115, v102, v103
    s_waitcnt lgkmcnt(4)
    s_nop 0
    v_mfma_f32_32x32x16_bf16 v[64:79], v[144:147], v[112:115], v[64:79]
    v_mad_u32_u24 v8, v6, 10, v5
    v_and_b32 v8, 2047, v8
    v_cvt_f32_u32 v8, v8
    v_fma_f32 v104, v15, v96, -v104
    v_fma_f32 v105, v15, v97, -v105
    v_fma_f32 v106, v15, v98, -v106
    v_fma_f32 v107, v15, v99, -v107
    v_mfma_f32_32x32x16_bf16 v[80:95], v[148:151], v[112:115], v[80:95]
    v_mul_f32 v8, 0x3a000000, v8
    v_cos_f32 v24, v8
    v_sin_f32 v26, v8
    v_mad_u32_u24 v8, v6, 11, v5
    v_fma_f32 v108, v15, v100, -v108
    v_fma_f32 v109, v15, v101, -v109
    v_fma_f32 v110, v15, v102, -v110
    v_fma_f32 v111, v15, v103, -v111
    ds_read_b128 v[136:139], v177 offset:512
    ds_read_b128 v[140:143], v179 offset:512
    v_cvt_pk_bf16_f32 v116, v104, v105
    v_cvt_pk_bf16_f32 v117, v106, v107
    v_cvt_pk_bf16_f32 v118, v108, v109
    v_cvt_pk_bf16_f32 v119, v110, v111
    s_waitcnt lgkmcnt(4)
    s_nop 0
    v_mfma_f32_32x32x16_bf16 v[64:79], v[152:155], v[116:119], v[64:79]
    v_and_b32 v8, 2047, v8
    v_cvt_f32_u32 v8, v8
    v_mul_f32 v8, 0x3a000000, v8
    v_fma_f32 v96, v15, v104, -v96
    v_fma_f32 v97, v15, v105, -v97
    v_fma_f32 v98, v15, v106, -v98
    v_fma_f32 v99, v15, v107, -v99
    v_mfma_f32_32x32x16_bf16 v[80:95], v[156:159], v[116:119], v[80:95]
    v_cos_f32 v25, v8
    v_sin_f32 v27, v8
    v_cvt_pk_bf16_f32 v163, v24, v25
    v_cvt_pk_bf16_f32 v171, -v26, -v27
    v_fma_f32 v100, v15, v108, -v100
    v_fma_f32 v101, v15, v109, -v101
    v_fma_f32 v102, v15, v110, -v102
    v_fma_f32 v103, v15, v111, -v103
    ds_read_b128 v[144:147], v180 offset:512
    ds_read_b128 v[148:151], v182 offset:512
    v_cvt_pk_bf16_f32 v112, v96, v97
    v_cvt_pk_bf16_f32 v113, v98, v99
    v_cvt_pk_bf16_f32 v114, v100, v101
    v_cvt_pk_bf16_f32 v115, v102, v103
    s_waitcnt lgkmcnt(4)
    s_nop 0
    v_mfma_f32_32x32x16_bf16 v[64:79], v[128:131], v[112:115], v[64:79]
    v_mad_u32_u24 v8, v6, 16, v5
    v_and_b32 v8, 2047, v8
    v_cvt_f32_u32 v8, v8
    v_fma_f32 v104, v15, v96, -v104
    v_fma_f32 v105, v15, v97, -v105
    v_fma_f32 v106, v15, v98, -v106
    v_fma_f32 v107, v15, v99, -v107
    v_mfma_f32_32x32x16_bf16 v[80:95], v[132:135], v[112:115], v[80:95]
    v_mul_f32 v8, 0x3a000000, v8
    v_cos_f32 v24, v8
    v_sin_f32 v26, v8
    v_mad_u32_u24 v8, v6, 17, v5
    v_fma_f32 v108, v15, v100, -v108
    v_fma_f32 v109, v15, v101, -v109
    v_fma_f32 v110, v15, v102, -v110
    v_fma_f32 v111, v15, v103, -v111
    ds_read_b128 v[152:155], v181 offset:512
    ds_read_b128 v[156:159], v183 offset:512
    v_cvt_pk_bf16_f32 v116, v104, v105
    v_cvt_pk_bf16_f32 v117, v106, v107
    v_cvt_pk_bf16_f32 v118, v108, v109
    v_cvt_pk_bf16_f32 v119, v110, v111
    s_waitcnt lgkmcnt(4)
    s_nop 0
    v_mfma_f32_32x32x16_bf16 v[64:79], v[136:139], v[116:119], v[64:79]
    v_and_b32 v8, 2047, v8
    v_cvt_f32_u32 v8, v8
    v_mul_f32 v8, 0x3a000000, v8
    v_fma_f32 v96, v15, v104, -v96
    v_fma_f32 v97, v15, v105, -v97
    v_fma_f32 v98, v15, v106, -v98
    v_fma_f32 v99, v15, v107, -v99
    v_mfma_f32_32x32x16_bf16 v[80:95], v[140:143], v[116:119], v[80:95]
    v_cos_f32 v25, v8
    v_sin_f32 v27, v8
    v_cvt_pk_bf16_f32 v164, v24, v25
    v_cvt_pk_bf16_f32 v172, -v26, -v27
    v_fma_f32 v100, v15, v108, -v100
    v_fma_f32 v101, v15, v109, -v101
    v_fma_f32 v102, v15, v110, -v102
    v_fma_f32 v103, v15, v111, -v103
    ds_read_b128 v[128:131], v176 offset:768
    ds_read_b128 v[132:135], v178 offset:768
    v_cvt_pk_bf16_f32 v112, v96, v97
    v_cvt_pk_bf16_f32 v113, v98, v99
    v_cvt_pk_bf16_f32 v114, v100, v101
    v_cvt_pk_bf16_f32 v115, v102, v103
    s_waitcnt lgkmcnt(4)
    s_nop 0
    v_mfma_f32_32x32x16_bf16 v[64:79], v[144:147], v[112:115], v[64:79]
    v_mad_u32_u24 v8, v6, 18, v5
    v_and_b32 v8, 2047, v8
    v_cvt_f32_u32 v8, v8
    v_fma_f32 v104, v15, v96, -v104
    v_fma_f32 v105, v15, v97, -v105
    v_fma_f32 v106, v15, v98, -v106
    v_fma_f32 v107, v15, v99, -v107
    v_mfma_f32_32x32x16_bf16 v[80:95], v[148:151], v[112:115], v[80:95]
    v_mul_f32 v8, 0x3a000000, v8
    v_cos_f32 v24, v8
    v_sin_f32 v26, v8
    v_mad_u32_u24 v8, v6, 19, v5
    v_fma_f32 v108, v15, v100, -v108
    v_fma_f32 v109, v15, v101, -v109
    v_fma_f32 v110, v15, v102, -v110
    v_fma_f32 v111, v15, v103, -v111
    ds_read_b128 v[136:139], v177 offset:768
    ds_read_b128 v[140:143], v179 offset:768
    v_cvt_pk_bf16_f32 v116, v104, v105
    v_cvt_pk_bf16_f32 v117, v106, v107
    v_cvt_pk_bf16_f32 v118, v108, v109
    v_cvt_pk_bf16_f32 v119, v110, v111
    s_waitcnt lgkmcnt(4)
    s_nop 0
    v_mfma_f32_32x32x16_bf16 v[64:79], v[152:155], v[116:119], v[64:79]
    v_and_b32 v8, 2047, v8
    v_cvt_f32_u32 v8, v8
    v_mul_f32 v8, 0x3a000000, v8
    v_fma_f32 v96, v15, v104, -v96
    v_fma_f32 v97, v15, v105, -v97
    v_fma_f32 v98, v15, v106, -v98
    v_fma_f32 v99, v15, v107, -v99
    v_mfma_f32_32x32x16_bf16 v[80:95], v[156:159], v[116:119], v[80:95]
    v_cos_f32 v25, v8
    v_sin_f32 v27, v8
    v_cvt_pk_bf16_f32 v165, v24, v25
    v_cvt_pk_bf16_f32 v173, -v26, -v27
    v_fma_f32 v100, v15, v108, -v100
    v_fma_f32 v101, v15, v109, -v101
    v_fma_f32 v102, v15, v110, -v102
    v_fma_f32 v103, v15, v111, -v103
    ds_read_b128 v[144:147], v180 offset:768
    ds_read_b128 v[148:151], v182 offset:768
    v_cvt_pk_bf16_f32 v112, v96, v97
    v_cvt_pk_bf16_f32 v113, v98, v99
    v_cvt_pk_bf16_f32 v114, v100, v101
    v_cvt_pk_bf16_f32 v115, v102, v103
    s_waitcnt lgkmcnt(4)
    s_nop 0
    v_mfma_f32_32x32x16_bf16 v[64:79], v[128:131], v[112:115], v[64:79]
    v_mad_u32_u24 v8, v6, 24, v5
    v_and_b32 v8, 2047, v8
    v_cvt_f32_u32 v8, v8
    v_fma_f32 v104, v15, v96, -v104
    v_fma_f32 v105, v15, v97, -v105
    v_fma_f32 v106, v15, v98, -v106
    v_fma_f32 v107, v15, v99, -v107
    v_mfma_f32_32x32x16_bf16 v[80:95], v[132:135], v[112:115], v[80:95]
    v_mul_f32 v8, 0x3a000000, v8
    v_cos_f32 v24, v8
    v_sin_f32 v26, v8
    v_mad_u32_u24 v8, v6, 25, v5
    v_fma_f32 v108, v15, v100, -v108
    v_fma_f32 v109, v15, v101, -v109
    v_fma_f32 v110, v15, v102, -v110
    v_fma_f32 v111, v15, v103, -v111
    ds_read_b128 v[152:155], v181 offset:768
    ds_read_b128 v[156:159], v183 offset:768
    v_cvt_pk_bf16_f32 v116, v104, v105
    v_cvt_pk_bf16_f32 v117, v106, v107
    v_cvt_pk_bf16_f32 v118, v108, v109
    v_cvt_pk_bf16_f32 v119, v110, v111
    s_waitcnt lgkmcnt(4)
    s_nop 0
    v_mfma_f32_32x32x16_bf16 v[64:79], v[136:139], v[116:119], v[64:79]
    v_and_b32 v8, 2047, v8
    v_cvt_f32_u32 v8, v8
    v_mul_f32 v8, 0x3a000000, v8
    v_fma_f32 v96, v15, v104, -v96
    v_fma_f32 v97, v15, v105, -v97
    v_fma_f32 v98, v15, v106, -v98
    v_fma_f32 v99, v15, v107, -v99
    v_mfma_f32_32x32x16_bf16 v[80:95], v[140:143], v[116:119], v[80:95]
    v_cos_f32 v25, v8
    v_sin_f32 v27, v8
    v_cvt_pk_bf16_f32 v166, v24, v25
    v_cvt_pk_bf16_f32 v174, -v26, -v27
    v_fma_f32 v100, v15, v108, -v100
    v_fma_f32 v101, v15, v109, -v101
    v_fma_f32 v102, v15, v110, -v102
    v_fma_f32 v103, v15, v111, -v103
    v_cvt_pk_bf16_f32 v112, v96, v97
    v_cvt_pk_bf16_f32 v113, v98, v99
    v_cvt_pk_bf16_f32 v114, v100, v101
    v_cvt_pk_bf16_f32 v115, v102, v103
    s_waitcnt lgkmcnt(2)
    s_nop 0
    v_mfma_f32_32x32x16_bf16 v[64:79], v[144:147], v[112:115], v[64:79]
    v_mad_u32_u24 v8, v6, 26, v5
    v_and_b32 v8, 2047, v8
    v_cvt_f32_u32 v8, v8
    v_fma_f32 v104, v15, v96, -v104
    v_fma_f32 v105, v15, v97, -v105
    v_fma_f32 v106, v15, v98, -v106
    v_fma_f32 v107, v15, v99, -v107
    v_mfma_f32_32x32x16_bf16 v[80:95], v[148:151], v[112:115], v[80:95]
    v_mul_f32 v8, 0x3a000000, v8
    v_cos_f32 v24, v8
    v_sin_f32 v26, v8
    v_mad_u32_u24 v8, v6, 27, v5
    v_fma_f32 v108, v15, v100, -v108
    v_fma_f32 v109, v15, v101, -v109
    v_fma_f32 v110, v15, v102, -v110
    v_fma_f32 v111, v15, v103, -v111
    v_cvt_pk_bf16_f32 v116, v104, v105
    v_cvt_pk_bf16_f32 v117, v106, v107
    v_cvt_pk_bf16_f32 v118, v108, v109
    v_cvt_pk_bf16_f32 v119, v110, v111
    s_waitcnt lgkmcnt(0)
    s_nop 0
    v_mfma_f32_32x32x16_bf16 v[64:79], v[152:155], v[116:119], v[64:79]
    v_and_b32 v8, 2047, v8
    v_cvt_f32_u32 v8, v8
    v_mul_f32 v8, 0x3a000000, v8
    v_mfma_f32_32x32x16_bf16 v[80:95], v[156:159], v[116:119], v[80:95]
    v_cos_f32 v25, v8
    v_sin_f32 v27, v8
    v_cvt_pk_bf16_f32 v167, v24, v25
    v_cvt_pk_bf16_f32 v175, -v26, -v27
    s_lshl_b32 s3, s49, 13
    s_lshl_b32 s4, s48, 12
    s_add_u32 s3, s3, s4
    s_add_u32 s3, s3, 45056
    v_lshl_add_u32 v4, v1, 4, s3
    v_cvt_pk_bf16_f32 v128, v64, v65
    v_cvt_pk_bf16_f32 v129, v66, v67
    v_cvt_pk_bf16_f32 v130, v68, v69
    v_cvt_pk_bf16_f32 v131, v70, v71
    v_cvt_pk_bf16_f32 v132, v72, v73
    v_cvt_pk_bf16_f32 v133, v74, v75
    v_cvt_pk_bf16_f32 v134, v76, v77
    v_cvt_pk_bf16_f32 v135, v78, v79
    v_cvt_pk_bf16_f32 v136, v80, v81
    v_cvt_pk_bf16_f32 v137, v82, v83
    v_cvt_pk_bf16_f32 v138, v84, v85
    v_cvt_pk_bf16_f32 v139, v86, v87
    v_cvt_pk_bf16_f32 v140, v88, v89
    v_cvt_pk_bf16_f32 v141, v90, v91
    v_cvt_pk_bf16_f32 v142, v92, v93
    v_cvt_pk_bf16_f32 v143, v94, v95
    v_mfma_f32_32x32x16_bf16 v[96:111], v[160:163], v[128:131], 0
    v_mfma_f32_32x32x16_bf16 v[96:111], v[164:167], v[132:135], v[96:111]
    v_mfma_f32_32x32x16_bf16 v[96:111], v[168:171], v[136:139], v[96:111]
    v_mfma_f32_32x32x16_bf16 v[96:111], v[172:175], v[140:143], v[96:111]
    s_nop 11
    ds_write_b128 v4, v[96:99] offset:0
    ds_write_b128 v4, v[100:103] offset:1024
    ds_write_b128 v4, v[104:107] offset:2048
    ds_write_b128 v4, v[108:111] offset:3072
    s_waitcnt lgkmcnt(0)
    s_barrier
    s_barrier
    s_barrier
L_fin:
L_exit:
    s_endpgm
L_p1_light:
    s_sub_u32 s5, s5, 22
    s_cmp_ge_u32 s5, 8
    s_cbranch_scc1 L_p1_idle
    s_lshl_b32 s46, s4, 1
    s_and_b32 s3, s5, 1
    s_add_u32 s46, s46, s3
    s_lshr_b32 s47, s5, 1
    s_lshl_b32 s51, s44, 10
    s_lshl_b32 s50, s46, 12
    s_lshl_b32 s60, s5, 3
    s_add_u32 s60, s60, s44
    v_lshrrev_b32 v5, 4, v1
    s_lshl_b32 s3, s44, 2
    v_add_u32 v5, s3, v5
    v_xor_b32 v6, v5, v1
    v_and_b32 v6, 15, v6
    v_lshlrev_b32 v6, 4, v6
    v_lshl_add_u32 v4, v5, 16, v6
    s_xor_b32 s3, s47, 0
    s_lshl_b32 s4, s3, 13
    s_add_u32 s54, s4, s51
    s_lshl_b32 s3, s3, 10
    s_add_u32 s55, s3, s50
    s_xor_b32 s3, s47, 1
    s_lshl_b32 s4, s3, 13
    s_add_u32 s56, s4, s51
    s_lshl_b32 s3, s3, 10
    s_add_u32 s57, s3, s50
    s_xor_b32 s3, s47, 2
    s_lshl_b32 s4, s3, 13
    s_add_u32 s58, s4, s51
    s_lshl_b32 s3, s3, 10
    s_add_u32 s59, s3, s50
    s_waitcnt lgkmcnt(0)
    s_mov_b64 s[8:9], s[64:65]
    s_mov_b32 s10, 2097152
    s_mov_b32 s11, 0x00020000
    s_add_u32 m0, s54, 0
    s_add_u32 s3, s55, 0
    buffer_load_dwordx4 v4, s[8:11], s3 offen lds
    s_add_u32 m0, s54, 67584
    s_add_u32 s3, s55, 256
    buffer_load_dwordx4 v4, s[8:11], s3 offen lds
    s_add_u32 m0, s54, 32768
    s_add_u32 s3, s55, 512
    buffer_load_dwordx4 v4, s[8:11], s3 offen lds
    s_add_u32 m0, s54, 100352
    s_add_u32 s3, s55, 768
    buffer_load_dwordx4 v4, s[8:11], s3 offen lds
    s_barrier
    s_xor_b32 s3, s47, 3
    s_lshl_b32 s4, s3, 13
    s_add_u32 s54, s4, s51
    s_lshl_b32 s3, s3, 10
    s_add_u32 s55, s3, s50
    s_add_u32 m0, s56, 0
    s_add_u32 s3, s57, 0
    buffer_load_dwordx4 v4, s[8:11], s3 offen lds
    s_add_u32 m0, s58, 0
    s_add_u32 s3, s59, 0
    buffer_load_dwordx4 v4, s[8:11], s3 offen lds
    s_add_u32 m0, s54, 0
    s_add_u32 s3, s55, 0
    buffer_load_dwordx4 v4, s[8:11], s3 offen lds
    s_add_u32 s4, s84, 14680064
    s_addc_u32 s5, s85, 0
    s_load_dword s45, s[4:5], 0
    s_mov_b64 s[12:13], s[72:73]
    s_mov_b32 s14, 1409024
    s_mov_b32 s15, 0x00020000
    s_mov_b64 s[16:17], s[84:85]
    s_mov_b32 s18, 16777216
    s_mov_b32 s19, 0x00020000
    s_mov_b64 s[20:21], s[74:75]
    s_mov_b32 s22, 8388608
    s_mov_b32 s23, 0x00020000
    s_mov_b64 s[24:25], s[66:67]
    s_mov_b32 s26, 1052672
    s_mov_b32 s27, 0x00020000
    s_mov_b64 s[28:29], s[68:69]
    s_mov_b32 s30, 1052672
    s_mov_b32 s31, 0x00020000
    s_mov_b64 s[32:33], s[76:77]
    s_mov_b32 s34, 4096
    s_mov_b32 s35, 0x00020000
    s_mov_b64 s[36:37], s[78:79]
    s_mov_b32 s38, 704512
    s_mov_b32 s39, 0x00020000
    s_mov_b64 s[40:41], s[80:81]
    s_mov_b32 s42, 2097152
    s_mov_b32 s43, 0x00020000
    s_and_b32 s48, s44, 3
    s_lshr_b32 s49, s44, 2
    v_and_b32 v10, 31, v1
    v_lshrrev_b32 v11, 5, v1
    s_lshl_b32 s52, s47, 1
    s_add_u32 s52, s52, s49
    s_lshl_b32 s53, s46, 2
    s_add_u32 s53, s53, s48
    s_lshl_b32 s3, s52, 5
    s_add_u32 s3, s3, 1
    v_add_u32 v14, s3, v10
    v_and_b32 v6, 15, v10
    v_xor_b32 v6, v6, v11
    v_lshlrev_b32 v6, 4, v6
    v_lshl_add_u32 v12, v10, 8, v6
    s_bfe_u32 s3, s44, 0x10001
    s_mul_i32 s3, s3, 67584
    s_lshl_b32 s4, s49, 15
    s_add_u32 s3, s3, s4
    s_lshl_b32 s4, s47, 13
    s_add_u32 s3, s3, s4
    s_and_b32 s4, s44, 1
    s_lshl_b32 s4, s4, 7
    v_xor_b32 v13, s4, v12
    v_add_u32 v13, s3, v13
    s_lshl_b32 s3, s44, 4
    s_add_u32 s3, s3, 135168
    v_lshlrev_b32 v20, 7, v10
    v_lshl_add_u32 v21, v11, 3, v20
    v_add_u32 v21, s3, v21
    v_lshl_add_u32 v20, v11, 6, v20
    v_mov_b32 v17, 0
    v_mov_b32 v18, 0
    v_mov_b32 v19, 0
    s_mov_b32 s62, 0x3f803f80
    s_lshl_b32 s3, s49, 9
    s_add_u32 s3, s3, 1
    v_lshl_add_u32 v5, v11, 4, s3
    v_mul_u32_u24 v5, v5, v14
    v_lshl_add_u32 v6, v14, 1, v5
    v_lshlrev_b32 v9, 5, v14
    v_sub_u32 v7, v5, v9
    v_sub_u32 v8, v6, v9
    v_and_b32 v5, 1023, v5
    v_and_b32 v6, 1023, v6
    v_and_b32 v7, 1023, v7
    v_and_b32 v8, 1023, v8
    v_and_b32 v9, 511, v14
    v_and_b32 v15, 31, v14
    v_cvt_f32_u32 v5, v5
    v_cvt_f32_u32 v6, v6
    v_cvt_f32_u32 v7, v7
    v_cvt_f32_u32 v8, v8
    v_cvt_f32_u32 v9, v9
    v_cvt_f32_u32 v15, v15
    v_mul_f32 v5, 0x3a800000, v5
    v_mul_f32 v6, 0x3a800000, v6
    v_mul_f32 v7, 0x3a800000, v7
    v_mul_f32 v8, 0x3a800000, v8
    v_mul_f32 v9, 0x3b000000, v9
    v_mul_f32 v15, 0x3d000000, v15
    v_cos_f32 v9, v9
    v_cos_f32 v15, v15
    v_cos_f32 v128, v5
    v_sin_f32 v144, v5
    v_cos_f32 v129, v6
    v_sin_f32 v145, v6
    v_cos_f32 v136, v7
    v_sin_f32 v152, v7
    v_cos_f32 v137, v8
    v_sin_f32 v153, v8
    v_add_f32 v9, v9, v9
    v_add_f32 v15, v15, v15
    v_lshlrev_b32 v16, 31, v14
    v_or_b32 v16, 1.0, v16
    v_fma_f32 v130, v9, v129, -v128
    v_fma_f32 v138, v9, v137, -v136
    v_fma_f32 v146, v9, v145, -v144
    v_fma_f32 v154, v9, v153, -v152
    v_fma_f32 v131, v9, v130, -v129
    v_fma_f32 v139, v9, v138, -v137
    v_fma_f32 v147, v9, v146, -v145
    v_fma_f32 v155, v9, v154, -v153
    v_fma_f32 v132, v9, v131, -v130
    v_fma_f32 v140, v9, v139, -v138
    v_fma_f32 v148, v9, v147, -v146
    v_fma_f32 v156, v9, v155, -v154
    v_fma_f32 v133, v9, v132, -v131
    v_fma_f32 v141, v9, v140, -v139
    v_fma_f32 v149, v9, v148, -v147
    v_fma_f32 v157, v9, v156, -v155
    v_fma_f32 v134, v9, v133, -v132
    v_fma_f32 v142, v9, v141, -v140
    v_fma_f32 v150, v9, v149, -v148
    v_fma_f32 v158, v9, v157, -v156
    v_fma_f32 v135, v9, v134, -v133
    v_fma_f32 v143, v9, v142, -v141
    v_fma_f32 v151, v9, v150, -v149
    v_fma_f32 v159, v9, v158, -v157
    v_lshlrev_b32 v5, 8, v11
    v_add_u32 v5, s53, v5
    v_mul_u32_u24 v5, v5, v10
    v_lshl_add_u32 v6, v10, 6, v5
    v_and_b32 v5, 2047, v5
    v_and_b32 v6, 2047, v6
    v_and_b32 v7, 31, v10
    v_cvt_f32_u32 v5, v5
    v_cvt_f32_u32 v6, v6
    v_cvt_f32_u32 v7, v7
    v_mul_f32 v5, 0x3a000000, v5
    v_mul_f32 v6, 0x3a000000, v6
    v_mul_f32 v7, 0x3d000000, v7
    v_cos_f32 v7, v7
    v_cos_f32 v192, v5
    v_sin_f32 v224, v5
    v_cos_f32 v193, v6
    v_sin_f32 v225, v6
    v_add_f32 v7, v7, v7
    v_fma_f32 v194, v7, v193, -v192
    v_fma_f32 v226, v7, v225, -v224
    v_fma_f32 v195, v7, v194, -v193
    v_fma_f32 v227, v7, v226, -v225
    v_fma_f32 v196, v7, v195, -v194
    v_fma_f32 v228, v7, v227, -v226
    v_fma_f32 v197, v7, v196, -v195
    v_fma_f32 v229, v7, v228, -v227
    v_fma_f32 v198, v7, v197, -v196
    v_fma_f32 v230, v7, v229, -v228
    v_fma_f32 v199, v7, v198, -v197
    v_fma_f32 v231, v7, v230, -v229
    v_fma_f32 v200, v7, v199, -v198
    v_fma_f32 v232, v7, v231, -v230
    v_fma_f32 v201, v7, v200, -v199
    v_fma_f32 v233, v7, v232, -v231
    v_fma_f32 v202, v7, v201, -v200
    v_fma_f32 v234, v7, v233, -v232
    v_fma_f32 v203, v7, v202, -v201
    v_fma_f32 v235, v7, v234, -v233
    v_fma_f32 v204, v7, v203, -v202
    v_fma_f32 v236, v7, v235, -v234
    v_fma_f32 v205, v7, v204, -v203
    v_fma_f32 v237, v7, v236, -v235
    v_fma_f32 v206, v7, v205, -v204
    v_fma_f32 v238, v7, v237, -v236
    v_fma_f32 v207, v7, v206, -v205
    v_fma_f32 v239, v7, v238, -v237
    v_fma_f32 v208, v7, v207, -v206
    v_fma_f32 v240, v7, v239, -v238
    v_fma_f32 v209, v7, v208, -v207
    v_fma_f32 v241, v7, v240, -v239
    v_fma_f32 v210, v7, v209, -v208
    v_fma_f32 v242, v7, v241, -v240
    v_fma_f32 v211, v7, v210, -v209
    v_fma_f32 v243, v7, v242, -v241
    v_fma_f32 v212, v7, v211, -v210
    v_fma_f32 v244, v7, v243, -v242
    v_fma_f32 v213, v7, v212, -v211
    v_fma_f32 v245, v7, v244, -v243
    v_fma_f32 v214, v7, v213, -v212
    v_fma_f32 v246, v7, v245, -v244
    v_fma_f32 v215, v7, v214, -v213
    v_fma_f32 v247, v7, v246, -v245
    v_fma_f32 v216, v7, v215, -v214
    v_fma_f32 v248, v7, v247, -v246
    v_fma_f32 v217, v7, v216, -v215
    v_fma_f32 v249, v7, v248, -v247
    v_fma_f32 v218, v7, v217, -v216
    v_fma_f32 v250, v7, v249, -v248
    v_fma_f32 v219, v7, v218, -v217
    v_fma_f32 v251, v7, v250, -v249
    v_cvt_pk_bf16_f32 v64, v192, v193
    v_cvt_pk_bf16_f32 v72, v224, v225
    v_cvt_pk_bf16_f32 v80, -v224, -v225
    v_cvt_pk_bf16_f32 v65, v194, v195
    v_cvt_pk_bf16_f32 v73, v226, v227
    v_cvt_pk_bf16_f32 v81, -v226, -v227
    v_cvt_pk_bf16_f32 v66, v200, v201
    v_cvt_pk_bf16_f32 v74, v232, v233
    v_cvt_pk_bf16_f32 v82, -v232, -v233
    v_cvt_pk_bf16_f32 v67, v202, v203
    v_cvt_pk_bf16_f32 v75, v234, v235
    v_cvt_pk_bf16_f32 v83, -v234, -v235
    v_cvt_pk_bf16_f32 v68, v208, v209
    v_cvt_pk_bf16_f32 v76, v240, v241
    v_cvt_pk_bf16_f32 v84, -v240, -v241
    v_cvt_pk_bf16_f32 v69, v210, v211
    v_cvt_pk_bf16_f32 v77, v242, v243
    v_cvt_pk_bf16_f32 v85, -v242, -v243
    v_cvt_pk_bf16_f32 v70, v216, v217
    v_cvt_pk_bf16_f32 v78, v248, v249
    v_cvt_pk_bf16_f32 v86, -v248, -v249
    v_cvt_pk_bf16_f32 v71, v218, v219
    v_cvt_pk_bf16_f32 v79, v250, v251
    v_cvt_pk_bf16_f32 v87, -v250, -v251
    s_add_u32 m0, s56, 32768
    s_add_u32 s3, s57, 512
    buffer_load_dwordx4 v4, s[8:11], s3 offen lds
    s_add_u32 m0, s58, 32768
    s_add_u32 s3, s59, 512
    buffer_load_dwordx4 v4, s[8:11], s3 offen lds
    s_add_u32 m0, s54, 32768
    s_add_u32 s3, s55, 512
    buffer_load_dwordx4 v4, s[8:11], s3 offen lds
    s_waitcnt lgkmcnt(0)
    s_mul_i32 s45, s45, 0x9E3779B1
    s_add_u32 s45, s45, 0x7F4A7C15
    s_waitcnt vmcnt(6)
    s_barrier
    v_xor_b32 v24, 0, v13
    ds_read_b128 v[192:195], v24
    v_xor_b32 v24, 32, v13
    ds_read_b128 v[196:199], v24
    v_xor_b32 v24, 64, v13
    ds_read_b128 v[200:203], v24
    v_xor_b32 v24, 96, v13
    ds_read_b128 v[204:207], v24
    s_lshl_b32 s3, s48, 13
    s_lshl_b32 s4, s49, 15
    s_add_u32 s3, s3, s4
    v_add_u32 v12, s3, v12
    v_xor_b32 v13, 0x8000, v12
    v_xor_b32 v224, 0, v12
    v_xor_b32 v232, 0, v13
    v_xor_b32 v225, 32, v12
    v_xor_b32 v233, 32, v13
    v_xor_b32 v226, 64, v12
    v_xor_b32 v234, 64, v13
    v_xor_b32 v227, 96, v12
    v_xor_b32 v235, 96, v13
    v_xor_b32 v228, 128, v12
    v_xor_b32 v236, 128, v13
    v_xor_b32 v229, 160, v12
    v_xor_b32 v237, 160, v13
    v_xor_b32 v230, 192, v12
    v_xor_b32 v238, 192, v13
    v_xor_b32 v231, 224, v12
    v_xor_b32 v239, 224, v13
    s_waitcnt lgkmcnt(3)
    v_dot2c_f32_bf16 v17, s62, v192
    v_dot2c_f32_bf16 v19, v192, v192
    v_dot2c_f32_bf16 v18, s62, v193
    v_dot2c_f32_bf16 v19, v193, v193
    v_dot2c_f32_bf16 v17, s62, v194
    v_dot2c_f32_bf16 v19, v194, v194
    v_dot2c_f32_bf16 v18, s62, v195
    v_dot2c_f32_bf16 v19, v195, v195
    s_waitcnt lgkmcnt(2)
    v_dot2c_f32_bf16 v17, s62, v196
    v_dot2c_f32_bf16 v19, v196, v196
    v_dot2c_f32_bf16 v18, s62, v197
    v_dot2c_f32_bf16 v19, v197, v197
    v_dot2c_f32_bf16 v17, s62, v198
    v_dot2c_f32_bf16 v19, v198, v198
    v_dot2c_f32_bf16 v18, s62, v199
    v_dot2c_f32_bf16 v19, v199, v199
    s_waitcnt lgkmcnt(1)
    v_dot2c_f32_bf16 v17, s62, v200
    v_dot2c_f32_bf16 v19, v200, v200
    v_dot2c_f32_bf16 v18, s62, v201
    v_dot2c_f32_bf16 v19, v201, v201
    v_dot2c_f32_bf16 v17, s62, v202
    v_dot2c_f32_bf16 v19, v202, v202
    v_dot2c_f32_bf16 v18, s62, v203
    v_dot2c_f32_bf16 v19, v203, v203
    s_waitcnt lgkmcnt(0)
    v_dot2c_f32_bf16 v17, s62, v204
    v_dot2c_f32_bf16 v19, v204, v204
    v_dot2c_f32_bf16 v18, s62, v205
    v_dot2c_f32_bf16 v19, v205, v205
    v_dot2c_f32_bf16 v17, s62, v206
    v_dot2c_f32_bf16 v19, v206, v206
    v_dot2c_f32_bf16 v18, s62, v207
    v_dot2c_f32_bf16 v19, v207, v207
    s_nop 1
    v_add_f32 v18, v17, v18
    ds_write_b64 v21, v[18:19]
    s_waitcnt lgkmcnt(0)
    s_barrier
    s_cmp_lg_u32 s44, 0
    s_cbranch_scc1 L_soft_dft_ln
    v_add_u32 v22, 135168, v20
    ds_read_b128 v[192:195], v22 offset:0
    ds_read_b128 v[196:199], v22 offset:16
    ds_read_b128 v[200:203], v22 offset:32
    ds_read_b128 v[204:207], v22 offset:48
    v_lshlrev_b32 v22, 10, v10
    v_lshl_add_u32 v22, v11, 30, v22
    s_lshl_b32 s3, s46, 2
    s_add_u32 s3, s3, s47
    s_lshl_b32 s3, s3, 4
    s_add_u32 s3, s3, 14155776
    s_waitcnt lgkmcnt(0)
    v_add_f32 v192, v192, v200
    v_add_f32 v193, v193, v201
    v_add_f32 v194, v194, v202
    v_add_f32 v195, v195, v203
    v_add_f32 v196, v196, v204
    v_add_f32 v197, v197, v205
    v_add_f32 v198, v198, v206
    v_add_f32 v199, v199, v207
    v_add_f32 v192, v192, v196
    v_add_f32 v193, v193, v197
    v_add_f32 v194, v194, v198
    v_add_f32 v195, v195, v199
    v_add_f32 v192, v192, v194
    v_add_f32 v193, v193, v195
    v_mov_b32 v194, v192
    v_mov_b32 v195, v193
    s_nop 0
    v_permlane32_swap_b32 v192, v194
    v_permlane32_swap_b32 v193, v195
    v_add_f32 v192, v192, v194
    v_add_f32 v193, v193, v195
    v_mul_f32 v192, 0x3b000000, v192
    v_mul_f32 v193, 0x3b000000, v193
    v_fma_f32 v193, -v192, v192, v193
    v_add_f32 v193, 0x3727c5ac, v193
    v_rsq_f32 v194, v193
    v_mov_b32 v193, s45
    v_mov_b32 v195, s45
    buffer_store_dwordx4 v[192:195], v22, s[16:19], s3 offen sc1
L_soft_dft_ln:
    s_add_u32 m0, s56, 67584
    s_add_u32 s3, s57, 256
    buffer_load_dwordx4 v4, s[8:11], s3 offen lds
    s_add_u32 m0, s58, 67584
    s_add_u32 s3, s59, 256
    buffer_load_dwordx4 v4, s[8:11], s3 offen lds
    s_add_u32 m0, s54, 67584
    s_add_u32 s3, s55, 256
    buffer_load_dwordx4 v4, s[8:11], s3 offen lds
    s_add_u32 m0, s56, 100352
    s_add_u32 s3, s57, 768
    buffer_load_dwordx4 v4, s[8:11], s3 offen lds
    s_add_u32 m0, s58, 100352
    s_add_u32 s3, s59, 768
    buffer_load_dwordx4 v4, s[8:11], s3 offen lds
    s_add_u32 m0, s54, 100352
    s_add_u32 s3, s55, 768
    buffer_load_dwordx4 v4, s[8:11], s3 offen lds
    s_lshl_b32 s63, s47, 8
    s_lshl_b32 s3, s46, 2
    s_add_u32 s63, s63, s3
    s_add_u32 s63, s63, 14686976
    s_and_b32 s4, s2, 7
    s_lshr_b32 s5, s2, 3
    s_and_b32 s6, s4, 1
    s_lshr_b32 s72, s5, 3
    s_and_b32 s68, s5, 7
    s_lshl_b32 s67, s4, 2
    s_add_u32 s67, s67, s72
    s_and_b32 s3, s5, 3
    s_lshl_b32 s3, s3, 1
    s_bfe_u32 s64, s5, 0x10002
    s_xor_b32 s64, s64, s6
    s_xor_b32 s64, s64, 1
    s_add_u32 s3, s3, s64
    s_cmp_eq_u32 s72, 2
    s_cselect_b32 s3, s3, s68
    s_lshr_b32 s64, s4, 1
    s_lshl_b32 s64, s64, 3
    s_add_u32 s64, s64, s3
    s_xor_b32 s3, s3, s6
    s_and_b32 s3, s3, 1
    s_xor_b32 s3, s3, 1
    s_sub_u32 s65, 22, s3
    s_mul_i32 s65, s65, s6
    s_mul_i32 s4, s72, 5
    s_add_u32 s65, s65, s4
    s_cmp_eq_u32 s72, 3
    s_cselect_b32 s4, s3, 0
    s_add_u32 s65, s65, s4
    s_add_u32 s3, s3, s72
    s_cmp_ge_u32 s3, 3
    s_cselect_b32 s66, 6, 5
    s_lshl_b32 s69, s64, 13
    s_lshl_b32 s3, s44, 9
    s_add_u32 s69, s69, s3
    s_mul_i32 s70, s44, 8448
    v_lshrrev_b32 v9, 2, v1
    v_lshlrev_b32 v9, 18, v9
    v_and_b32 v8, 3, v1
    v_lshl_add_u32 v9, v8, 7, v9
    s_lshr_b32 s4, s72, 1
    s_lshl_b32 s4, s4, 12
    s_and_b32 s3, s72, 1
    s_lshl_b32 s3, s3, 22
    s_add_u32 s3, s3, s4
    s_add_u32 s59, s3, s69
    v_lshlrev_b32 v26, 10, v10
    s_lshl_b32 s3, s53, 4
    s_add_u32 s58, s3, 14155776
    v_cvt_pk_bf16_f32 v160, v128, v129
    v_cvt_pk_bf16_f32 v161, v130, v131
    v_cvt_pk_bf16_f32 v162, v132, v133
    v_cvt_pk_bf16_f32 v163, v134, v135
    v_cvt_pk_bf16_f32 v164, v144, v145
    v_cvt_pk_bf16_f32 v165, v146, v147
    v_cvt_pk_bf16_f32 v166, v148, v149
    v_cvt_pk_bf16_f32 v167, v150, v151
    s_waitcnt vmcnt(6)
    s_barrier
    ds_read_b128 v[192:195], v224
    ds_read_b128 v[196:199], v232
    ds_read_b128 v[200:203], v225
    ds_read_b128 v[204:207], v233
    ds_read_b128 v[208:211], v226
    ds_read_b128 v[212:215], v234
    s_waitcnt lgkmcnt(4)
    v_mfma_f32_32x32x16_bf16 v[96:111], v[192:195], v[160:163], 0
    v_fma_f32 v136, v15, v128, -v136
    v_fma_f32 v137, v15, v129, -v137
    v_fma_f32 v138, v15, v130, -v138
    v_fma_f32 v139, v15, v131, -v139
    v_fma_f32 v140, v15, v132, -v140
    v_fma_f32 v141, v15, v133, -v141
    v_mfma_f32_32x32x16_bf16 v[112:127], v[192:195], v[164:167], 0
    v_fma_f32 v142, v15, v134, -v142
    v_fma_f32 v143, v15, v135, -v143
    v_fma_f32 v152, v15, v144, -v152
    v_fma_f32 v153, v15, v145, -v153
    v_fma_f32 v154, v15, v146, -v154
    v_fma_f32 v155, v15, v147, -v155
    v_mfma_f32_32x32x16_bf16 v[176:191], v[196:199], v[160:163], 0
    v_fma_f32 v156, v15, v148, -v156
    v_fma_f32 v157, v15, v149, -v157
    v_fma_f32 v158, v15, v150, -v158
    v_fma_f32 v159, v15, v151, -v159
    v_cvt_pk_bf16_f32 v168, v136, v137
    v_cvt_pk_bf16_f32 v169, v138, v139
    v_mfma_f32_32x32x16_bf16 v[32:47], v[196:199], v[164:167], 0
    v_cvt_pk_bf16_f32 v170, v140, v141
    v_cvt_pk_bf16_f32 v171, v142, v143
    v_cvt_pk_bf16_f32 v172, v152, v153
    v_cvt_pk_bf16_f32 v173, v154, v155
    v_cvt_pk_bf16_f32 v174, v156, v157
    v_cvt_pk_bf16_f32 v175, v158, v159
    ds_read_b128 v[216:219], v227
    ds_read_b128 v[220:223], v235
    s_waitcnt lgkmcnt(4)
    v_mfma_f32_32x32x16_bf16 v[96:111], v[200:203], v[168:171], v[96:111]
    v_fma_f32 v128, v15, v136, -v128
    v_fma_f32 v129, v15, v137, -v129
    v_fma_f32 v130, v15, v138, -v130
    v_fma_f32 v131, v15, v139, -v131
    v_fma_f32 v132, v15, v140, -v132
    v_fma_f32 v133, v15, v141, -v133
    v_mfma_f32_32x32x16_bf16 v[112:127], v[200:203], v[172:175], v[112:127]
    v_fma_f32 v134, v15, v142, -v134
    v_fma_f32 v135, v15, v143, -v135
    v_fma_f32 v144, v15, v152, -v144
    v_fma_f32 v145, v15, v153, -v145
    v_fma_f32 v146, v15, v154, -v146
    v_fma_f32 v147, v15, v155, -v147
    v_mfma_f32_32x32x16_bf16 v[176:191], v[204:207], v[168:171], v[176:191]
    v_fma_f32 v148, v15, v156, -v148
    v_fma_f32 v149, v15, v157, -v149
    v_fma_f32 v150, v15, v158, -v150
    v_fma_f32 v151, v15, v159, -v151
    v_cvt_pk_bf16_f32 v160, v128, v129
    v_cvt_pk_bf16_f32 v161, v130, v131
    v_mfma_f32_32x32x16_bf16 v[32:47], v[204:207], v[172:175], v[32:47]
    v_cvt_pk_bf16_f32 v162, v132, v133
    v_cvt_pk_bf16_f32 v163, v134, v135
    v_cvt_pk_bf16_f32 v164, v144, v145
    v_cvt_pk_bf16_f32 v165, v146, v147
    v_cvt_pk_bf16_f32 v166, v148, v149
    v_cvt_pk_bf16_f32 v167, v150, v151
    ds_read_b128 v[192:195], v228
    ds_read_b128 v[196:199], v236
    buffer_load_dwordx4 v[28:31], v26, s[16:19], s58 offen sc1
    s_waitcnt lgkmcnt(4)
    v_mfma_f32_32x32x16_bf16 v[96:111], v[208:211], v[160:163], v[96:111]
    v_fma_f32 v136, v15, v128, -v136
    v_fma_f32 v137, v15, v129, -v137
    v_fma_f32 v138, v15, v130, -v138
    v_fma_f32 v139, v15, v131, -v139
    v_fma_f32 v140, v15, v132, -v140
    v_fma_f32 v141, v15, v133, -v141
    v_mfma_f32_32x32x16_bf16 v[112:127], v[208:211], v[164:167], v[112:127]
    v_fma_f32 v142, v15, v134, -v142
    v_fma_f32 v143, v15, v135, -v143
    v_fma_f32 v152, v15, v144, -v152
    v_fma_f32 v153, v15, v145, -v153
    v_fma_f32 v154, v15, v146, -v154
    v_fma_f32 v155, v15, v147, -v155
    v_mfma_f32_32x32x16_bf16 v[176:191], v[212:215], v[160:163], v[176:191]
    v_fma_f32 v156, v15, v148, -v156
    v_fma_f32 v157, v15, v149, -v157
    v_fma_f32 v158, v15, v150, -v158
    v_fma_f32 v159, v15, v151, -v159
    v_cvt_pk_bf16_f32 v168, v136, v137
    v_cvt_pk_bf16_f32 v169, v138, v139
    v_mfma_f32_32x32x16_bf16 v[32:47], v[212:215], v[164:167], v[32:47]
    v_cvt_pk_bf16_f32 v170, v140, v141
    v_cvt_pk_bf16_f32 v171, v142, v143
    v_cvt_pk_bf16_f32 v172, v152, v153
    v_cvt_pk_bf16_f32 v173, v154, v155
    v_cvt_pk_bf16_f32 v174, v156, v157
    v_cvt_pk_bf16_f32 v175, v158, v159
    ds_read_b128 v[200:203], v229
    ds_read_b128 v[204:207], v237
    s_waitcnt lgkmcnt(4)
    v_mfma_f32_32x32x16_bf16 v[96:111], v[216:219], v[168:171], v[96:111]
    v_fma_f32 v128, v15, v136, -v128
    v_fma_f32 v129, v15, v137, -v129
    v_fma_f32 v130, v15, v138, -v130
    v_fma_f32 v131, v15, v139, -v131
    v_fma_f32 v132, v15, v140, -v132
    v_fma_f32 v133, v15, v141, -v133
    v_mfma_f32_32x32x16_bf16 v[112:127], v[216:219], v[172:175], v[112:127]
    v_fma_f32 v134, v15, v142, -v134
    v_fma_f32 v135, v15, v143, -v135
    v_fma_f32 v144, v15, v152, -v144
    v_fma_f32 v145, v15, v153, -v145
    v_fma_f32 v146, v15, v154, -v146
    v_fma_f32 v147, v15, v155, -v147
    v_mfma_f32_32x32x16_bf16 v[176:191], v[220:223], v[168:171], v[176:191]
    v_fma_f32 v148, v15, v156, -v148
    v_fma_f32 v149, v15, v157, -v149
    v_fma_f32 v150, v15, v158, -v150
    v_fma_f32 v151, v15, v159, -v151
    v_cvt_pk_bf16_f32 v160, v128, v129
    v_cvt_pk_bf16_f32 v161, v130, v131
    v_mfma_f32_32x32x16_bf16 v[32:47], v[220:223], v[172:175], v[32:47]
    v_cvt_pk_bf16_f32 v162, v132, v133
    v_cvt_pk_bf16_f32 v163, v134, v135
    v_cvt_pk_bf16_f32 v164, v144, v145
    v_cvt_pk_bf16_f32 v165, v146, v147
    v_cvt_pk_bf16_f32 v166, v148, v149
    v_cvt_pk_bf16_f32 v167, v150, v151
    ds_read_b128 v[208:211], v230
    ds_read_b128 v[212:215], v238
    s_waitcnt lgkmcnt(4)
    v_mfma_f32_32x32x16_bf16 v[96:111], v[192:195], v[160:163], v[96:111]
    v_fma_f32 v136, v15, v128, -v136
    v_fma_f32 v137, v15, v129, -v137
    v_fma_f32 v138, v15, v130, -v138
    v_fma_f32 v139, v15, v131, -v139
    v_fma_f32 v140, v15, v132, -v140
    v_fma_f32 v141, v15, v133, -v141
    v_mfma_f32_32x32x16_bf16 v[112:127], v[192:195], v[164:167], v[112:127]
    v_fma_f32 v142, v15, v134, -v142
    v_fma_f32 v143, v15, v135, -v143
    v_fma_f32 v152, v15, v144, -v152
    v_fma_f32 v153, v15, v145, -v153
    v_fma_f32 v154, v15, v146, -v154
    v_fma_f32 v155, v15, v147, -v155
    v_mfma_f32_32x32x16_bf16 v[176:191], v[196:199], v[160:163], v[176:191]
    v_fma_f32 v156, v15, v148, -v156
    v_fma_f32 v157, v15, v149, -v157
    v_fma_f32 v158, v15, v150, -v158
    v_fma_f32 v159, v15, v151, -v159
    v_cvt_pk_bf16_f32 v168, v136, v137
    v_cvt_pk_bf16_f32 v169, v138, v139
    v_mfma_f32_32x32x16_bf16 v[32:47], v[196:199], v[164:167], v[32:47]
    v_cvt_pk_bf16_f32 v170, v140, v141
    v_cvt_pk_bf16_f32 v171, v142, v143
    v_cvt_pk_bf16_f32 v172, v152, v153
    v_cvt_pk_bf16_f32 v173, v154, v155
    v_cvt_pk_bf16_f32 v174, v156, v157
    v_cvt_pk_bf16_f32 v175, v158, v159
    ds_read_b128 v[216:219], v231
    ds_read_b128 v[220:223], v239
    s_waitcnt lgkmcnt(4)
    v_mfma_f32_32x32x16_bf16 v[96:111], v[200:203], v[168:171], v[96:111]
    v_fma_f32 v128, v15, v136, -v128
    v_fma_f32 v129, v15, v137, -v129
    v_fma_f32 v130, v15, v138, -v130
    v_fma_f32 v131, v15, v139, -v131
    v_fma_f32 v132, v15, v140, -v132
    v_fma_f32 v133, v15, v141, -v133
    v_mfma_f32_32x32x16_bf16 v[112:127], v[200:203], v[172:175], v[112:127]
    v_fma_f32 v134, v15, v142, -v134
    v_fma_f32 v135, v15, v143, -v135
    v_fma_f32 v144, v15, v152, -v144
    v_fma_f32 v145, v15, v153, -v145
    v_fma_f32 v146, v15, v154, -v146
    v_fma_f32 v147, v15, v155, -v147
    v_mfma_f32_32x32x16_bf16 v[176:191], v[204:207], v[168:171], v[176:191]
    v_fma_f32 v148, v15, v156, -v148
    v_fma_f32 v149, v15, v157, -v149
    v_fma_f32 v150, v15, v158, -v150
    v_fma_f32 v151, v15, v159, -v151
    v_cvt_pk_bf16_f32 v160, v128, v129
    v_cvt_pk_bf16_f32 v161, v130, v131
    v_mfma_f32_32x32x16_bf16 v[32:47], v[204:207], v[172:175], v[32:47]
    v_cvt_pk_bf16_f32 v162, v132, v133
    v_cvt_pk_bf16_f32 v163, v134, v135
    v_cvt_pk_bf16_f32 v164, v144, v145
    v_cvt_pk_bf16_f32 v165, v146, v147
    v_cvt_pk_bf16_f32 v166, v148, v149
    v_cvt_pk_bf16_f32 v167, v150, v151
    s_waitcnt vmcnt(0)
    v_xor_b32 v20, s45, v29
    v_xor_b32 v21, s45, v31
    v_or_b32 v20, v20, v21
    v_cmp_ne_u32 vcc, 0, v20
    s_nop 3
    s_cbranch_vccz L_soft_got_dln
    s_mov_b32 s61, 0
L_soft_again_dln:
    buffer_load_dwordx4 v[28:31], v26, s[16:19], s58 offen sc1
    s_waitcnt vmcnt(0)
    v_xor_b32 v20, s45, v29
    v_xor_b32 v21, s45, v31
    v_or_b32 v20, v20, v21
    v_cmp_ne_u32 vcc, 0, v20
    s_add_u32 s61, s61, 1
    s_cmp_gt_u32 s61, 20000
    s_nop 1
    s_cbranch_scc1 L_soft_got_dln
    s_cbranch_vccnz L_soft_again_dln
L_soft_got_dln:
    s_lshl_b32 s3, s44, 7
    s_add_u32 s3, s3, 139264
    v_lshl_add_u32 v7, v10, 2, s3
    ds_write_b32 v7, v30
    v_lshl_add_u32 v7, v11, 4, s3
    s_waitcnt vmcnt(1)
    s_barrier
    v_add_u32 v224, 67584, v224
    v_add_u32 v232, 67584, v232
    ds_read_b128 v[192:195], v224
    ds_read_b128 v[196:199], v232
    s_waitcnt lgkmcnt(5)
    v_mfma_f32_32x32x16_bf16 v[96:111], v[208:211], v[160:163], v[96:111]
    v_fma_f32 v136, v15, v128, -v136
    v_fma_f32 v137, v15, v129, -v137
    v_fma_f32 v138, v15, v130, -v138
    v_fma_f32 v139, v15, v131, -v139
    v_fma_f32 v140, v15, v132, -v140
    v_fma_f32 v141, v15, v133, -v141
    v_mfma_f32_32x32x16_bf16 v[112:127], v[208:211], v[164:167], v[112:127]
    v_fma_f32 v142, v15, v134, -v142
    v_fma_f32 v143, v15, v135, -v143
    v_fma_f32 v152, v15, v144, -v152
    v_fma_f32 v153, v15, v145, -v153
    v_fma_f32 v154, v15, v146, -v154
    v_fma_f32 v155, v15, v147, -v155
    v_mfma_f32_32x32x16_bf16 v[176:191], v[212:215], v[160:163], v[176:191]
    v_fma_f32 v156, v15, v148, -v156
    v_fma_f32 v157, v15, v149, -v157
    v_fma_f32 v158, v15, v150, -v158
    v_fma_f32 v159, v15, v151, -v159
    v_cvt_pk_bf16_f32 v168, v136, v137
    v_cvt_pk_bf16_f32 v169, v138, v139
    v_mfma_f32_32x32x16_bf16 v[32:47], v[212:215], v[164:167], v[32:47]
    v_cvt_pk_bf16_f32 v170, v140, v141
    v_cvt_pk_bf16_f32 v171, v142, v143
    v_cvt_pk_bf16_f32 v172, v152, v153
    v_cvt_pk_bf16_f32 v173, v154, v155
    v_cvt_pk_bf16_f32 v174, v156, v157
    v_cvt_pk_bf16_f32 v175, v158, v159
    v_add_u32 v225, 67584, v225
    v_add_u32 v233, 67584, v233
    ds_read_b128 v[200:203], v225
    ds_read_b128 v[204:207], v233
    buffer_load_dword v27, v9, s[20:23], s59 offen
    s_waitcnt lgkmcnt(5)
    v_mfma_f32_32x32x16_bf16 v[96:111], v[216:219], v[168:171], v[96:111]
    v_fma_f32 v128, v15, v136, -v128
    v_fma_f32 v129, v15, v137, -v129
    v_fma_f32 v130, v15, v138, -v130
    v_fma_f32 v131, v15, v139, -v131
    v_fma_f32 v132, v15, v140, -v132
    v_fma_f32 v133, v15, v141, -v133
    v_mfma_f32_32x32x16_bf16 v[112:127], v[216:219], v[172:175], v[112:127]
    v_fma_f32 v134, v15, v142, -v134
    v_fma_f32 v135, v15, v143, -v135
    v_fma_f32 v144, v15, v152, -v144
    v_fma_f32 v145, v15, v153, -v145
    v_fma_f32 v146, v15, v154, -v146
    v_fma_f32 v147, v15, v155, -v147
    v_mfma_f32_32x32x16_bf16 v[176:191], v[220:223], v[168:171], v[176:191]
    v_fma_f32 v148, v15, v156, -v148
    v_fma_f32 v149, v15, v157, -v149
    v_fma_f32 v150, v15, v158, -v150
    v_fma_f32 v151, v15, v159, -v151
    v_cvt_pk_bf16_f32 v160, v128, v129
    v_cvt_pk_bf16_f32 v161, v130, v131
    v_mfma_f32_32x32x16_bf16 v[32:47], v[220:223], v[172:175], v[32:47]
    v_cvt_pk_bf16_f32 v162, v132, v133
    v_cvt_pk_bf16_f32 v163, v134, v135
    v_cvt_pk_bf16_f32 v164, v144, v145
    v_cvt_pk_bf16_f32 v165, v146, v147
    v_cvt_pk_bf16_f32 v166, v148, v149
    v_cvt_pk_bf16_f32 v167, v150, v151
    s_waitcnt lgkmcnt(4)
    ds_read_b128 v[48:51], v7 offset:0
    ds_read_b128 v[52:55], v7 offset:32
    ds_read_b128 v[56:59], v7 offset:64
    ds_read_b128 v[60:63], v7 offset:96
    v_add_u32 v226, 67584, v226
    v_add_u32 v234, 67584, v234
    ds_read_b128 v[208:211], v226
    ds_read_b128 v[212:215], v234
    s_waitcnt lgkmcnt(8)
    v_mfma_f32_32x32x16_bf16 v[96:111], v[192:195], v[160:163], v[96:111]
    v_fma_f32 v136, v15, v128, -v136
    v_fma_f32 v137, v15, v129, -v137
    v_fma_f32 v138, v15, v130, -v138
    v_fma_f32 v139, v15, v131, -v139
    v_fma_f32 v140, v15, v132, -v140
    v_fma_f32 v141, v15, v133, -v141
    v_mfma_f32_32x32x16_bf16 v[112:127], v[192:195], v[164:167], v[112:127]
    v_fma_f32 v142, v15, v134, -v142
    v_fma_f32 v143, v15, v135, -v143
    v_fma_f32 v152, v15, v144, -v152
    v_fma_f32 v153, v15, v145, -v153
    v_fma_f32 v154, v15, v146, -v154
    v_fma_f32 v155, v15, v147, -v155
    v_mfma_f32_32x32x16_bf16 v[176:191], v[196:199], v[160:163], v[176:191]
    v_fma_f32 v156, v15, v148, -v156
    v_fma_f32 v157, v15, v149, -v157
    v_fma_f32 v158, v15, v150, -v158
    v_fma_f32 v159, v15, v151, -v159
    v_cvt_pk_bf16_f32 v168, v136, v137
    v_cvt_pk_bf16_f32 v169, v138, v139
    v_mfma_f32_32x32x16_bf16 v[32:47], v[196:199], v[164:167], v[32:47]
    v_cvt_pk_bf16_f32 v170, v140, v141
    v_cvt_pk_bf16_f32 v171, v142, v143
    v_cvt_pk_bf16_f32 v172, v152, v153
    v_cvt_pk_bf16_f32 v173, v154, v155
    v_cvt_pk_bf16_f32 v174, v156, v157
    v_cvt_pk_bf16_f32 v175, v158, v159
    v_add_u32 v227, 67584, v227
    v_add_u32 v235, 67584, v235
    ds_read_b128 v[216:219], v227
    ds_read_b128 v[220:223], v235
    s_waitcnt lgkmcnt(8)
    v_mfma_f32_32x32x16_bf16 v[96:111], v[200:203], v[168:171], v[96:111]
    v_fma_f32 v128, v15, v136, -v128
    v_fma_f32 v129, v15, v137, -v129
    v_fma_f32 v130, v15, v138, -v130
    v_fma_f32 v131, v15, v139, -v131
    v_fma_f32 v132, v15, v140, -v132
    v_fma_f32 v133, v15, v141, -v133
    v_mfma_f32_32x32x16_bf16 v[112:127], v[200:203], v[172:175], v[112:127]
    v_fma_f32 v134, v15, v142, -v134
    v_fma_f32 v135, v15, v143, -v135
    v_fma_f32 v144, v15, v152, -v144
    v_fma_f32 v145, v15, v153, -v145
    v_fma_f32 v146, v15, v154, -v146
    v_fma_f32 v147, v15, v155, -v147
    v_mfma_f32_32x32x16_bf16 v[176:191], v[204:207], v[168:171], v[176:191]
    v_fma_f32 v148, v15, v156, -v148
    v_fma_f32 v149, v15, v157, -v149
    v_fma_f32 v150, v15, v158, -v150
    v_fma_f32 v151, v15, v159, -v151
    v_cvt_pk_bf16_f32 v160, v128, v129
    v_cvt_pk_bf16_f32 v161, v130, v131
    v_mfma_f32_32x32x16_bf16 v[32:47], v[204:207], v[172:175], v[32:47]
    v_cvt_pk_bf16_f32 v162, v132, v133
    v_cvt_pk_bf16_f32 v163, v134, v135
    v_cvt_pk_bf16_f32 v164, v144, v145
    v_cvt_pk_bf16_f32 v165, v146, v147
    v_cvt_pk_bf16_f32 v166, v148, v149
    v_cvt_pk_bf16_f32 v167, v150, v151
    v_add_u32 v228, 67584, v228
    v_add_u32 v236, 67584, v236
    ds_read_b128 v[192:195], v228
    ds_read_b128 v[196:199], v236
    s_waitcnt lgkmcnt(4)
    v_mfma_f32_32x32x16_bf16 v[96:111], v[208:211], v[160:163], v[96:111]
    v_fma_f32 v136, v15, v128, -v136
    v_fma_f32 v137, v15, v129, -v137
    v_fma_f32 v138, v15, v130, -v138
    v_fma_f32 v139, v15, v131, -v139
    v_fma_f32 v140, v15, v132, -v140
    v_fma_f32 v141, v15, v133, -v141
    v_mfma_f32_32x32x16_bf16 v[112:127], v[208:211], v[164:167], v[112:127]
    v_fma_f32 v142, v15, v134, -v142
    v_fma_f32 v143, v15, v135, -v143
    v_fma_f32 v152, v15, v144, -v152
    v_fma_f32 v153, v15, v145, -v153
    v_fma_f32 v154, v15, v146, -v154
    v_fma_f32 v155, v15, v147, -v155
    v_mfma_f32_32x32x16_bf16 v[176:191], v[212:215], v[160:163], v[176:191]
    v_fma_f32 v156, v15, v148, -v156
    v_fma_f32 v157, v15, v149, -v157
    v_fma_f32 v158, v15, v150, -v158
    v_fma_f32 v159, v15, v151, -v159
    v_cvt_pk_bf16_f32 v168, v136, v137
    v_cvt_pk_bf16_f32 v169, v138, v139
    v_mfma_f32_32x32x16_bf16 v[32:47], v[212:215], v[164:167], v[32:47]
    v_cvt_pk_bf16_f32 v170, v140, v141
    v_cvt_pk_bf16_f32 v171, v142, v143
    v_cvt_pk_bf16_f32 v172, v152, v153
    v_cvt_pk_bf16_f32 v173, v154, v155
    v_cvt_pk_bf16_f32 v174, v156, v157
    v_cvt_pk_bf16_f32 v175, v158, v159
    v_add_u32 v229, 67584, v229
    v_add_u32 v237, 67584, v237
    ds_read_b128 v[200:203], v229
    ds_read_b128 v[204:207], v237
    s_waitcnt lgkmcnt(4)
    v_mfma_f32_32x32x16_bf16 v[96:111], v[216:219], v[168:171], v[96:111]
    v_fma_f32 v128, v15, v136, -v128
    v_fma_f32 v129, v15, v137, -v129
    v_fma_f32 v130, v15, v138, -v130
    v_fma_f32 v131, v15, v139, -v131
    v_fma_f32 v132, v15, v140, -v132
    v_fma_f32 v133, v15, v141, -v133
    v_mfma_f32_32x32x16_bf16 v[112:127], v[216:219], v[172:175], v[112:127]
    v_fma_f32 v134, v15, v142, -v134
    v_fma_f32 v135, v15, v143, -v135
    v_fma_f32 v144, v15, v152, -v144
    v_fma_f32 v145, v15, v153, -v145
    v_fma_f32 v146, v15, v154, -v146
    v_fma_f32 v147, v15, v155, -v147
    v_mfma_f32_32x32x16_bf16 v[176:191], v[220:223], v[168:171], v[176:191]
    v_fma_f32 v148, v15, v156, -v148
    v_fma_f32 v149, v15, v157, -v149
    v_fma_f32 v150, v15, v158, -v150
    v_fma_f32 v151, v15, v159, -v151
    v_cvt_pk_bf16_f32 v160, v128, v129
    v_cvt_pk_bf16_f32 v161, v130, v131
    v_mfma_f32_32x32x16_bf16 v[32:47], v[220:223], v[172:175], v[32:47]
    v_cvt_pk_bf16_f32 v162, v132, v133
    v_cvt_pk_bf16_f32 v163, v134, v135
    v_cvt_pk_bf16_f32 v164, v144, v145
    v_cvt_pk_bf16_f32 v165, v146, v147
    v_cvt_pk_bf16_f32 v166, v148, v149
    v_cvt_pk_bf16_f32 v167, v150, v151
    v_add_u32 v230, 67584, v230
    v_add_u32 v238, 67584, v238
    ds_read_b128 v[208:211], v230
    ds_read_b128 v[212:215], v238
    s_waitcnt lgkmcnt(4)
    v_mfma_f32_32x32x16_bf16 v[96:111], v[192:195], v[160:163], v[96:111]
    v_fma_f32 v136, v15, v128, -v136
    v_fma_f32 v137, v15, v129, -v137
    v_fma_f32 v138, v15, v130, -v138
    v_fma_f32 v139, v15, v131, -v139
    v_fma_f32 v140, v15, v132, -v140
    v_fma_f32 v141, v15, v133, -v141
    v_mfma_f32_32x32x16_bf16 v[112:127], v[192:195], v[164:167], v[112:127]
    v_fma_f32 v142, v15, v134, -v142
    v_fma_f32 v143, v15, v135, -v143
    v_fma_f32 v152, v15, v144, -v152
    v_fma_f32 v153, v15, v145, -v153
    v_fma_f32 v154, v15, v146, -v154
    v_fma_f32 v155, v15, v147, -v155
    v_mfma_f32_32x32x16_bf16 v[176:191], v[196:199], v[160:163], v[176:191]
    v_fma_f32 v156, v15, v148, -v156
    v_fma_f32 v157, v15, v149, -v157
    v_fma_f32 v158, v15, v150, -v158
    v_fma_f32 v159, v15, v151, -v159
    v_cvt_pk_bf16_f32 v168, v136, v137
    v_cvt_pk_bf16_f32 v169, v138, v139
    v_mfma_f32_32x32x16_bf16 v[32:47], v[196:199], v[164:167], v[32:47]
    v_cvt_pk_bf16_f32 v170, v140, v141
    v_cvt_pk_bf16_f32 v171, v142, v143
    v_cvt_pk_bf16_f32 v172, v152, v153
    v_cvt_pk_bf16_f32 v173, v154, v155
    v_cvt_pk_bf16_f32 v174, v156, v157
    v_cvt_pk_bf16_f32 v175, v158, v159
    v_add_u32 v231, 67584, v231
    v_add_u32 v239, 67584, v239
    ds_read_b128 v[216:219], v231
    ds_read_b128 v[220:223], v239
    s_waitcnt lgkmcnt(4)
    v_mfma_f32_32x32x16_bf16 v[96:111], v[200:203], v[168:171], v[96:111]
    v_fma_f32 v128, v15, v136, -v128
    v_fma_f32 v129, v15, v137, -v129
    v_fma_f32 v130, v15, v138, -v130
    v_fma_f32 v131, v15, v139, -v131
    v_fma_f32 v132, v15, v140, -v132
    v_fma_f32 v133, v15, v141, -v133
    v_mfma_f32_32x32x16_bf16 v[112:127], v[200:203], v[172:175], v[112:127]
    v_fma_f32 v134, v15, v142, -v134
    v_fma_f32 v135, v15, v143, -v135
    v_fma_f32 v144, v15, v152, -v144
    v_fma_f32 v145, v15, v153, -v145
    v_fma_f32 v146, v15, v154, -v146
    v_fma_f32 v147, v15, v155, -v147
    v_mfma_f32_32x32x16_bf16 v[176:191], v[204:207], v[168:171], v[176:191]
    v_fma_f32 v148, v15, v156, -v148
    v_fma_f32 v149, v15, v157, -v149
    v_fma_f32 v150, v15, v158, -v150
    v_fma_f32 v151, v15, v159, -v151
    v_cvt_pk_bf16_f32 v160, v128, v129
    v_cvt_pk_bf16_f32 v161, v130, v131
    v_mfma_f32_32x32x16_bf16 v[32:47], v[204:207], v[172:175], v[32:47]
    v_cvt_pk_bf16_f32 v162, v132, v133
    v_cvt_pk_bf16_f32 v163, v134, v135
    v_cvt_pk_bf16_f32 v164, v144, v145
    v_cvt_pk_bf16_f32 v165, v146, v147
    v_cvt_pk_bf16_f32 v166, v148, v149
    v_cvt_pk_bf16_f32 v167, v150, v151
    s_waitcnt lgkmcnt(2)
    v_mfma_f32_32x32x16_bf16 v[96:111], v[208:211], v[160:163], v[96:111]
    v_fma_f32 v136, v15, v128, -v136
    v_fma_f32 v137, v15, v129, -v137
    v_fma_f32 v138, v15, v130, -v138
    v_fma_f32 v139, v15, v131, -v139
    v_fma_f32 v140, v15, v132, -v140
    v_fma_f32 v141, v15, v133, -v141
    v_mfma_f32_32x32x16_bf16 v[112:127], v[208:211], v[164:167], v[112:127]
    v_fma_f32 v142, v15, v134, -v142
    v_fma_f32 v143, v15, v135, -v143
    v_fma_f32 v152, v15, v144, -v152
    v_fma_f32 v153, v15, v145, -v153
    v_fma_f32 v154, v15, v146, -v154
    v_fma_f32 v155, v15, v147, -v155
    v_mfma_f32_32x32x16_bf16 v[176:191], v[212:215], v[160:163], v[176:191]
    v_fma_f32 v156, v15, v148, -v156
    v_fma_f32 v157, v15, v149, -v157
    v_fma_f32 v158, v15, v150, -v158
    v_fma_f32 v159, v15, v151, -v159
    v_cvt_pk_bf16_f32 v168, v136, v137
    v_cvt_pk_bf16_f32 v169, v138, v139
    v_mfma_f32_32x32x16_bf16 v[32:47], v[212:215], v[164:167], v[32:47]
    v_cvt_pk_bf16_f32 v170, v140, v141
    v_cvt_pk_bf16_f32 v171, v142, v143
    v_cvt_pk_bf16_f32 v172, v152, v153
    v_cvt_pk_bf16_f32 v173, v154, v155
    v_cvt_pk_bf16_f32 v174, v156, v157
    v_cvt_pk_bf16_f32 v175, v158, v159
    s_waitcnt lgkmcnt(0)
    v_mfma_f32_32x32x16_bf16 v[96:111], v[216:219], v[168:171], v[96:111]
    v_mfma_f32_32x32x16_bf16 v[112:127], v[216:219], v[172:175], v[112:127]
    v_mfma_f32_32x32x16_bf16 v[176:191], v[220:223], v[168:171], v[176:191]
    v_mfma_f32_32x32x16_bf16 v[32:47], v[220:223], v[172:175], v[32:47]
    s_barrier
    s_nop 9
    v_fma_f32 v96, v16, v176, v96
    v_fma_f32 v112, v16, v32, v112
    v_fma_f32 v97, v16, v177, v97
    v_fma_f32 v113, v16, v33, v113
    v_fma_f32 v98, v16, v178, v98
    v_fma_f32 v114, v16, v34, v114
    v_fma_f32 v99, v16, v179, v99
    v_fma_f32 v115, v16, v35, v115
    v_fma_f32 v100, v16, v180, v100
    v_fma_f32 v116, v16, v36, v116
    v_fma_f32 v101, v16, v181, v101
    v_fma_f32 v117, v16, v37, v117
    v_fma_f32 v102, v16, v182, v102
    v_fma_f32 v118, v16, v38, v118
    v_fma_f32 v103, v16, v183, v103
    v_fma_f32 v119, v16, v39, v119
    v_fma_f32 v104, v16, v184, v104
    v_fma_f32 v120, v16, v40, v120
    v_fma_f32 v105, v16, v185, v105
    v_fma_f32 v121, v16, v41, v121
    v_fma_f32 v106, v16, v186, v106
    v_fma_f32 v122, v16, v42, v122
    v_fma_f32 v107, v16, v187, v107
    v_fma_f32 v123, v16, v43, v123
    v_fma_f32 v108, v16, v188, v108
    v_fma_f32 v124, v16, v44, v124
    v_fma_f32 v109, v16, v189, v109
    v_fma_f32 v125, v16, v45, v125
    v_fma_f32 v110, v16, v190, v110
    v_fma_f32 v126, v16, v46, v126
    v_fma_f32 v111, v16, v191, v111
    v_fma_f32 v127, v16, v47, v127
    v_mul_f32 v96, v96, v48
    v_mul_f32 v112, -v112, v48
    v_mul_f32 v97, v97, v49
    v_mul_f32 v113, -v113, v49
    v_mul_f32 v98, v98, v50
    v_mul_f32 v114, -v114, v50
    v_mul_f32 v99, v99, v51
    v_mul_f32 v115, -v115, v51
    v_mul_f32 v100, v100, v52
    v_mul_f32 v116, -v116, v52
    v_mul_f32 v101, v101, v53
    v_mul_f32 v117, -v117, v53
    v_mul_f32 v102, v102, v54
    v_mul_f32 v118, -v118, v54
    v_mul_f32 v103, v103, v55
    v_mul_f32 v119, -v119, v55
    v_mul_f32 v104, v104, v56
    v_mul_f32 v120, -v120, v56
    v_mul_f32 v105, v105, v57
    v_mul_f32 v121, -v121, v57
    v_mul_f32 v106, v106, v58
    v_mul_f32 v122, -v122, v58
    v_mul_f32 v107, v107, v59
    v_mul_f32 v123, -v123, v59
    v_mul_f32 v108, v108, v60
    v_mul_f32 v124, -v124, v60
    v_mul_f32 v109, v109, v61
    v_mul_f32 v125, -v125, v61
    v_mul_f32 v110, v110, v62
    v_mul_f32 v126, -v126, v62
    v_mul_f32 v111, v111, v63
    v_mul_f32 v127, -v127, v63
    v_cvt_pk_bf16_f32 v160, v96, v97
    v_cvt_pk_bf16_f32 v168, v112, v113
    v_cvt_pk_bf16_f32 v161, v98, v99
    v_cvt_pk_bf16_f32 v169, v114, v115
    v_cvt_pk_bf16_f32 v162, v100, v101
    v_cvt_pk_bf16_f32 v170, v116, v117
    v_cvt_pk_bf16_f32 v163, v102, v103
    v_cvt_pk_bf16_f32 v171, v118, v119
    v_cvt_pk_bf16_f32 v164, v104, v105
    v_cvt_pk_bf16_f32 v172, v120, v121
    v_cvt_pk_bf16_f32 v165, v106, v107
    v_cvt_pk_bf16_f32 v173, v122, v123
    v_cvt_pk_bf16_f32 v166, v108, v109
    v_cvt_pk_bf16_f32 v174, v124, v125
    v_cvt_pk_bf16_f32 v167, v110, v111
    v_cvt_pk_bf16_f32 v175, v126, v127
    v_mfma_f32_32x32x16_bf16 v[96:111], v[64:67], v[160:163], 0
    v_mfma_f32_32x32x16_bf16 v[112:127], v[64:67], v[168:171], 0
    v_mfma_f32_32x32x16_bf16 v[96:111], v[68:71], v[164:167], v[96:111]
    v_mfma_f32_32x32x16_bf16 v[112:127], v[68:71], v[172:175], v[112:127]
    v_mfma_f32_32x32x16_bf16 v[96:111], v[72:75], v[168:171], v[96:111]
    v_mfma_f32_32x32x16_bf16 v[112:127], v[80:83], v[160:163], v[112:127]
    v_mfma_f32_32x32x16_bf16 v[96:111], v[76:79], v[172:175], v[96:111]
    v_mfma_f32_32x32x16_bf16 v[112:127], v[84:87], v[164:167], v[112:127]
    s_lshl_b32 s3, s52, 13
    s_lshl_b32 s4, s53, 7
    s_add_u32 s56, s3, s4
    v_lshlrev_b32 v22, 18, v11
    v_lshl_add_u32 v22, v10, 2, v22
    v_lshrrev_b32 v5, 5, v1
    v_and_b32 v6, 31, v1
    v_xor_b32 v6, v6, v5
    v_lshlrev_b32 v6, 4, v6
    v_lshl_add_u32 v4, v5, 18, v6
    v_bfe_u32 v5, v1, 1, 3
    v_mul_u32_u24 v5, 1056, v5
    v_and_b32 v2, 1, v1
    v_lshl_add_u32 v5, v2, 9, v5
    v_lshrrev_b32 v6, 4, v1
    v_xor_b32 v6, v6, v2
    v_lshl_add_u32 v5, v6, 4, v5
    v_add_u32 v5, s70, v5
    v_add_u32 v6, 96256, v5
    v_cvt_pk_bf16_f32 v64, v96, v112
    s_add_u32 s3, s56, 6291456
    buffer_store_dword v64, v22, s[16:19], s3 offen sc1
    v_cvt_pk_bf16_f32 v65, v97, v113
    s_add_u32 s3, s56, 6356992
    buffer_store_dword v65, v22, s[16:19], s3 offen sc1
    v_cvt_pk_bf16_f32 v66, v98, v114
    s_add_u32 s3, s56, 6422528
    buffer_store_dword v66, v22, s[16:19], s3 offen sc1
    v_cvt_pk_bf16_f32 v67, v99, v115
    s_add_u32 s3, s56, 6488064
    buffer_store_dword v67, v22, s[16:19], s3 offen sc1
    v_cvt_pk_bf16_f32 v68, v100, v116
    s_add_u32 s3, s56, 6815744
    buffer_store_dword v68, v22, s[16:19], s3 offen sc1
    v_cvt_pk_bf16_f32 v69, v101, v117
    s_add_u32 s3, s56, 6881280
    buffer_store_dword v69, v22, s[16:19], s3 offen sc1
    v_cvt_pk_bf16_f32 v70, v102, v118
    s_add_u32 s3, s56, 6946816
    buffer_store_dword v70, v22, s[16:19], s3 offen sc1
    v_cvt_pk_bf16_f32 v71, v103, v119
    s_add_u32 s3, s56, 7012352
    buffer_store_dword v71, v22, s[16:19], s3 offen sc1
    v_cvt_pk_bf16_f32 v72, v104, v120
    s_add_u32 s3, s56, 7340032
    buffer_store_dword v72, v22, s[16:19], s3 offen sc1
    v_cvt_pk_bf16_f32 v73, v105, v121
    s_add_u32 s3, s56, 7405568
    buffer_store_dword v73, v22, s[16:19], s3 offen sc1
    v_cvt_pk_bf16_f32 v74, v106, v122
    s_add_u32 s3, s56, 7471104
    buffer_store_dword v74, v22, s[16:19], s3 offen sc1
    v_cvt_pk_bf16_f32 v75, v107, v123
    s_add_u32 s3, s56, 7536640
    buffer_store_dword v75, v22, s[16:19], s3 offen sc1
    v_cvt_pk_bf16_f32 v76, v108, v124
    s_add_u32 s3, s56, 7864320
    buffer_store_dword v76, v22, s[16:19], s3 offen sc1
    v_cvt_pk_bf16_f32 v77, v109, v125
    s_add_u32 s3, s56, 7929856
    buffer_store_dword v77, v22, s[16:19], s3 offen sc1
    v_cvt_pk_bf16_f32 v78, v110, v126
    s_add_u32 s3, s56, 7995392
    buffer_store_dword v78, v22, s[16:19], s3 offen sc1
    v_cvt_pk_bf16_f32 v79, v111, v127
    s_add_u32 s3, s56, 8060928
    buffer_store_dword v79, v22, s[16:19], s3 offen sc1
    s_barrier
    s_xor_b32 s7, s72, 0
    s_lshr_b32 s79, s7, 1
    s_lshl_b32 s79, s79, 12
    s_and_b32 s7, s7, 1
    s_lshl_b32 s7, s7, 22
    s_add_u32 s79, s79, s7
    s_add_u32 s79, s79, s69
    s_add_u32 m0, s70, 0
    s_add_u32 s7, s79, 0
    buffer_load_dwordx4 v4, s[20:23], s7 offen lds
    s_add_u32 m0, s70, 1056
    s_add_u32 s7, s79, 524288
    buffer_load_dwordx4 v4, s[20:23], s7 offen lds
    s_add_u32 m0, s70, 2112
    s_add_u32 s7, s79, 1048576
    buffer_load_dwordx4 v4, s[20:23], s7 offen lds
    s_add_u32 m0, s70, 3168
    s_add_u32 s7, s79, 1572864
    buffer_load_dwordx4 v4, s[20:23], s7 offen lds
    s_add_u32 m0, s70, 4224
    s_add_u32 s7, s79, 2097152
    buffer_load_dwordx4 v4, s[20:23], s7 offen lds
    s_add_u32 m0, s70, 5280
    s_add_u32 s7, s79, 2621440
    buffer_load_dwordx4 v4, s[20:23], s7 offen lds
    s_add_u32 m0, s70, 6336
    s_add_u32 s7, s79, 3145728
    buffer_load_dwordx4 v4, s[20:23], s7 offen lds
    s_add_u32 m0, s70, 7392
    s_add_u32 s7, s79, 3670016
    buffer_load_dwordx4 v4, s[20:23], s7 offen lds
    s_waitcnt vmcnt(8)
    s_barrier
    s_cmp_lg_u32 s44, 0
    s_cbranch_scc1 L_soft_dft_f
    v_mul_u32_u24 v2, 4096, v1
    v_cmp_gt_u32 vcc, 4, v1
    v_mov_b32 v3, 0x40000000
    s_nop 0
    v_cndmask_b32 v2, v3, v2, vcc
    v_mov_b32 v3, s45
    buffer_store_dword v3, v2, s[16:19], s63 offen sc1
L_soft_dft_f:
    s_mov_b32 s63, 0x40000000
    s_xor_b32 s7, s72, 1
    s_lshr_b32 s79, s7, 1
    s_lshl_b32 s79, s79, 12
    s_and_b32 s7, s7, 1
    s_lshl_b32 s7, s7, 22
    s_add_u32 s79, s79, s7
    s_add_u32 s79, s79, s69
    s_add_u32 m0, s70, 96256
    s_add_u32 s7, s79, 0
    buffer_load_dwordx4 v4, s[20:23], s7 offen lds
    s_add_u32 m0, s70, 97312
    s_add_u32 s7, s79, 524288
    buffer_load_dwordx4 v4, s[20:23], s7 offen lds
    s_add_u32 m0, s70, 98368
    s_add_u32 s7, s79, 1048576
    buffer_load_dwordx4 v4, s[20:23], s7 offen lds
    s_add_u32 m0, s70, 99424
    s_add_u32 s7, s79, 1572864
    buffer_load_dwordx4 v4, s[20:23], s7 offen lds
    s_add_u32 m0, s70, 100480
    s_add_u32 s7, s79, 2097152
    buffer_load_dwordx4 v4, s[20:23], s7 offen lds
    s_add_u32 m0, s70, 101536
    s_add_u32 s7, s79, 2621440
    buffer_load_dwordx4 v4, s[20:23], s7 offen lds
    s_add_u32 m0, s70, 102592
    s_add_u32 s7, s79, 3145728
    buffer_load_dwordx4 v4, s[20:23], s7 offen lds
    s_add_u32 m0, s70, 103648
    s_add_u32 s7, s79, 3670016
    buffer_load_dwordx4 v4, s[20:23], s7 offen lds
    s_waitcnt vmcnt(8)
    ds_read_b128 v[128:131], v5 offset:0
    ds_read_b128 v[132:135], v5 offset:64
    ds_read_b128 v[136:139], v5 offset:128
    ds_read_b128 v[140:143], v5 offset:192
    ds_read_b128 v[144:147], v5 offset:256
    ds_read_b128 v[148:151], v5 offset:320
    ds_read_b128 v[152:155], v5 offset:384
    ds_read_b128 v[156:159], v5 offset:448
    s_waitcnt vmcnt(0) lgkmcnt(0)
    s_branch L_p2
L_p1_idle:
    s_sub_u32 s5, s5, 8
    s_and_b32 s3, s2, 7
    s_lshl_b32 s3, s3, 1
    s_add_u32 s3, s3, s5
    s_lshl_b32 s3, s3, 3
    s_add_u32 s60, s3, s44
    v_lshrrev_b32 v7, 4, v1
    v_mul_u32_u24 v7, 2752, v7
    v_and_b32 v8, 15, v1
    v_min_u32 v8, 11, v8
    v_lshl_add_u32 v7, v8, 7, v7
    s_mul_i32 s59, s60, 11008
    s_mul_i32 s58, s60, 5504
    v_min_u32 v8, 42, v1
    v_lshlrev_b32 v8, 7, v8
    s_waitcnt lgkmcnt(0)
    s_mov_b64 s[12:13], s[72:73]
    s_mov_b32 s14, 1409024
    s_mov_b32 s15, 0x00020000
    s_mov_b64 s[36:37], s[78:79]
    s_mov_b32 s38, 704512
    s_mov_b32 s39, 0x00020000
    buffer_load_dword v26, v7, s[12:15], s59 offen
    s_add_u32 s4, s84, 14680064
    s_addc_u32 s5, s85, 0
    s_load_dword s45, s[4:5], 0
    s_mov_b64 s[8:9], s[64:65]
    s_mov_b32 s10, 2097152
    s_mov_b32 s11, 0x00020000
    s_mov_b64 s[16:17], s[84:85]
    s_mov_b32 s18, 16777216
    s_mov_b32 s19, 0x00020000
    s_mov_b64 s[20:21], s[74:75]
    s_mov_b32 s22, 8388608
    s_mov_b32 s23, 0x00020000
    s_mov_b64 s[24:25], s[66:67]
    s_mov_b32 s26, 1052672
    s_mov_b32 s27, 0x00020000
    s_mov_b64 s[28:29], s[68:69]
    s_mov_b32 s30, 1052672
    s_mov_b32 s31, 0x00020000
    s_mov_b64 s[32:33], s[76:77]
    s_mov_b32 s34, 4096
    s_mov_b32 s35, 0x00020000
    s_mov_b64 s[40:41], s[80:81]
    s_mov_b32 s42, 2097152
    s_mov_b32 s43, 0x00020000
    s_mov_b32 s63, 0x40000000
    s_and_b32 s4, s2, 7
    s_lshr_b32 s5, s2, 3
    s_and_b32 s6, s4, 1
    s_lshr_b32 s72, s5, 3
    s_and_b32 s68, s5, 7
    s_lshl_b32 s67, s4, 2
    s_add_u32 s67, s67, s72
    s_and_b32 s3, s5, 3
    s_lshl_b32 s3, s3, 1
    s_bfe_u32 s64, s5, 0x10002
    s_xor_b32 s64, s64, s6
    s_xor_b32 s64, s64, 1
    s_add_u32 s3, s3, s64
    s_cmp_eq_u32 s72, 2
    s_cselect_b32 s3, s3, s68
    s_lshr_b32 s64, s4, 1
    s_lshl_b32 s64, s64, 3
    s_add_u32 s64, s64, s3
    s_xor_b32 s3, s3, s6
    s_and_b32 s3, s3, 1
    s_xor_b32 s3, s3, 1
    s_sub_u32 s65, 22, s3
    s_mul_i32 s65, s65, s6
    s_mul_i32 s4, s72, 5
    s_add_u32 s65, s65, s4
    s_cmp_eq_u32 s72, 3
    s_cselect_b32 s4, s3, 0
    s_add_u32 s65, s65, s4
    s_add_u32 s3, s3, s72
    s_cmp_ge_u32 s3, 3
    s_cselect_b32 s66, 6, 5
    s_lshl_b32 s69, s64, 13
    s_lshl_b32 s3, s44, 9
    s_add_u32 s69, s69, s3
    s_mul_i32 s70, s44, 8448
    buffer_load_dword v26, v8, s[36:39], s58 offen
    v_lshrrev_b32 v5, 5, v1
    v_and_b32 v6, 31, v1
    v_xor_b32 v6, v6, v5
    v_lshlrev_b32 v6, 4, v6
    v_lshl_add_u32 v4, v5, 18, v6
    v_lshlrev_b32 v7, 7, v1
    s_mul_i32 s3, s60, 8320
    buffer_load_dword v26, v7, s[24:27], s3 offen
    buffer_load_dword v26, v7, s[28:31], s3 offen
    v_bfe_u32 v5, v1, 1, 3
    v_mul_u32_u24 v5, 1056, v5
    v_and_b32 v2, 1, v1
    v_lshl_add_u32 v5, v2, 9, v5
    v_lshrrev_b32 v6, 4, v1
    v_xor_b32 v6, v6, v2
    v_lshl_add_u32 v5, v6, 4, v5
    v_add_u32 v5, s70, v5
    v_add_u32 v6, 96256, v5
    s_waitcnt lgkmcnt(0)
    s_mul_i32 s45, s45, 0x9E3779B1
    s_add_u32 s45, s45, 0x7F4A7C15
    s_xor_b32 s7, s72, 0
    s_lshr_b32 s79, s7, 1
    s_lshl_b32 s79, s79, 12
    s_and_b32 s7, s7, 1
    s_lshl_b32 s7, s7, 22
    s_add_u32 s79, s79, s7
    s_add_u32 s79, s79, s69
    s_add_u32 m0, s70, 0
    s_add_u32 s7, s79, 0
    buffer_load_dwordx4 v4, s[20:23], s7 offen lds
    s_add_u32 m0, s70, 1056
    s_add_u32 s7, s79, 524288
    buffer_load_dwordx4 v4, s[20:23], s7 offen lds
    s_add_u32 m0, s70, 2112
    s_add_u32 s7, s79, 1048576
    buffer_load_dwordx4 v4, s[20:23], s7 offen lds
    s_add_u32 m0, s70, 3168
    s_add_u32 s7, s79, 1572864
    buffer_load_dwordx4 v4, s[20:23], s7 offen lds
    s_add_u32 m0, s70, 4224
    s_add_u32 s7, s79, 2097152
    buffer_load_dwordx4 v4, s[20:23], s7 offen lds
    s_add_u32 m0, s70, 5280
    s_add_u32 s7, s79, 2621440
    buffer_load_dwordx4 v4, s[20:23], s7 offen lds
    s_add_u32 m0, s70, 6336
    s_add_u32 s7, s79, 3145728
    buffer_load_dwordx4 v4, s[20:23], s7 offen lds
    s_add_u32 m0, s70, 7392
    s_add_u32 s7, s79, 3670016
    buffer_load_dwordx4 v4, s[20:23], s7 offen lds
    s_xor_b32 s7, s72, 1
    s_lshr_b32 s79, s7, 1
    s_lshl_b32 s79, s79, 12
    s_and_b32 s7, s7, 1
    s_lshl_b32 s7, s7, 22
    s_add_u32 s79, s79, s7
    s_add_u32 s79, s79, s69
    s_add_u32 m0, s70, 96256
    s_add_u32 s7, s79, 0
    buffer_load_dwordx4 v4, s[20:23], s7 offen lds
    s_add_u32 m0, s70, 97312
    s_add_u32 s7, s79, 524288
    buffer_load_dwordx4 v4, s[20:23], s7 offen lds
    s_add_u32 m0, s70, 98368
    s_add_u32 s7, s79, 1048576
    buffer_load_dwordx4 v4, s[20:23], s7 offen lds
    s_add_u32 m0, s70, 99424
    s_add_u32 s7, s79, 1572864
    buffer_load_dwordx4 v4, s[20:23], s7 offen lds
    s_add_u32 m0, s70, 100480
    s_add_u32 s7, s79, 2097152
    buffer_load_dwordx4 v4, s[20:23], s7 offen lds
    s_add_u32 m0, s70, 101536
    s_add_u32 s7, s79, 2621440
    buffer_load_dwordx4 v4, s[20:23], s7 offen lds
    s_add_u32 m0, s70, 102592
    s_add_u32 s7, s79, 3145728
    buffer_load_dwordx4 v4, s[20:23], s7 offen lds
    s_add_u32 m0, s70, 103648
    s_add_u32 s7, s79, 3670016
    buffer_load_dwordx4 v4, s[20:23], s7 offen lds
    s_waitcnt vmcnt(8)
    ds_read_b128 v[128:131], v5 offset:0
    ds_read_b128 v[132:135], v5 offset:64
    ds_read_b128 v[136:139], v5 offset:128
    ds_read_b128 v[140:143], v5 offset:192
    ds_read_b128 v[144:147], v5 offset:256
    ds_read_b128 v[148:151], v5 offset:320
    ds_read_b128 v[152:155], v5 offset:384
    ds_read_b128 v[156:159], v5 offset:448
    s_waitcnt vmcnt(0) lgkmcnt(0)
    s_branch L_p2
L_end:
.section .rodata,"a"
.p2align 6
.amdhsa_kernel recurrent_scan__spectral_gfnet__mixer_gmlp__prompt_kernel
  .amdhsa_next_free_vgpr 256
  .amdhsa_next_free_sgpr 102
  .amdhsa_accum_offset 256
  .amdhsa_group_segment_fixed_size 0
  .amdhsa_kernarg_size 88
  .amdhsa_user_sgpr_count 2
  .amdhsa_user_sgpr_kernarg_segment_ptr 1
  .amdhsa_system_sgpr_workgroup_id_x 1
.end_amdhsa_kernel
```
